```python
import torch

def _softmax(x, axis=-1):
    return torch.softmax(x, dim=axis)
def _gelu(x):
    return torch.nn.functional.gelu(x, approximate="tanh")
def _silu(x):
    return torch.nn.functional.silu(x)
def _sigmoid(x):
    return torch.sigmoid(x)
def _layernorm(x, axis=-1, eps=1e-5):
    m = x.mean(dim=axis, keepdim=True)
    v = x.var(dim=axis, keepdim=True, unbiased=False)
    return (x - m) / torch.sqrt(v + eps)
def _scatter_add(tgt, idx, src, axis=0):
    return tgt.clone().index_add_(axis, idx, src)
def _segment_sum(src, seg, n):
    out = torch.zeros((n,) + src.shape[1:], dtype=src.dtype)
    return out.index_add_(0, seg, src)
def _pad(x, pw):
    flat = tuple(v for pair in reversed(pw) for v in pair)
    return torch.nn.functional.pad(x, flat)

kernel_name = 'recurrent_scan__sliding_block_cached__swiglu_ffn__decode'

def setup_inputs():

    _w = (lambda a: (lambda t: t.to(torch.bfloat16) if t.is_floating_point() else t)(torch.as_tensor(a)))
    def _A_setup():
        B, Sq, D = 8, 1, 512
        Hq, Hkv, Sk, Dh = 32, 8, 4096, 128
        assert Hq % Hkv == 0, (Hq, Hkv)
        return {
            "x": _w((lambda *s: torch.randn(*s, dtype=torch.bfloat16) * 0.05)(B, Sq, D)),
            "k_cache": _w((lambda *s: torch.randn(*s, dtype=torch.bfloat16) * 0.8)(B, Hkv, Sk, Dh)),
            "v_cache": _w((lambda *s: torch.randn(*s, dtype=torch.bfloat16) * 0.2)(B, Hkv, Sk, Dh)),
            "wq": _w((lambda *s: torch.randn(*s, dtype=torch.bfloat16) * 0.8)(D, Hq * Dh) * (D ** -0.5)),
            "wo": _w((lambda *s: torch.randn(*s, dtype=torch.bfloat16) * 0.2)(Hq * Dh, D) * ((Hq * Dh) ** -0.5)),
        }
    _A_in = _A_setup()

    def _B_setup():
        B, S, D, F = 8, 1, 512, 1792
        return {
            "x": _w((lambda *s: torch.randn(*s, dtype=torch.bfloat16) * 0.05)(B, S, D)),
            "w_gate": _w((lambda *s: torch.randn(*s, dtype=torch.bfloat16) * 0.1)(D, F)),
            "w_up": _w((lambda *s: torch.randn(*s, dtype=torch.bfloat16) * 0.1)(D, F)),
            "w_down": _w((lambda *s: torch.randn(*s, dtype=torch.bfloat16) * 0.1)(F, D)),
        }
    _B_in = _B_setup()

    return {
        "A_x": _A_in["x"],
        "A_k_cache": _A_in["k_cache"],
        "A_v_cache": _A_in["v_cache"],
        "A_wq": _A_in["wq"],
        "A_wo": _A_in["wo"],
        "B_x": _B_in["x"],
        "B_w_gate": _B_in["w_gate"],
        "B_w_up": _B_in["w_up"],
        "B_w_down": _B_in["w_down"],
    }

def reference(A_x, A_k_cache, A_v_cache, A_wq, A_wo, B_x, B_w_gate, B_w_up, B_w_down):
    def _A_ref(x, k_cache, v_cache, wq, wo):
        B, Sq, D = x.shape
        Hq, Dh = 32, 128
        Hkv, Sk = k_cache.shape[1], k_cache.shape[2]
        W = min(4096, max(256, Sk // 4))
        rep = Hq // Hkv
        q = (lambda x, *d: x.permute(*d))((x @ wq).reshape(B, Sq, Hq, Dh), 0, 2, 1, 3)
        k = (lambda x, n, axis: torch.repeat_interleave(x, n, dim=axis))(k_cache[:, :, Sk - W:, :], rep, axis=1)
        v = (lambda x, n, axis: torch.repeat_interleave(x, n, dim=axis))(v_cache[:, :, Sk - W:, :], rep, axis=1)
        scores = torch.einsum("bhqd,bhkd->bhqk", q, k) * (Dh ** -0.5)
        p = _softmax(scores, axis=-1)
        o = torch.einsum("bhqk,bhkd->bhqd", p, v)
        return (lambda x, *d: x.permute(*d))(o, 0, 2, 1, 3).reshape(B, Sq, Hq * Dh) @ wo

    def _B_ref(x, w_gate, w_up, w_down):
        g = _silu(x @ w_gate)
        u = x @ w_up
        return (g * u) @ w_down

    x = A_x
    xn = _layernorm(x, axis=-1)
    s = _A_ref(xn, A_k_cache, A_v_cache, A_wq, A_wo)
    g = _silu(_B_ref(xn, B_w_gate, B_w_up, B_w_down))
    return x + s * g
```

```asm
; @launch grid=(256,1,1) block=(448,1,1) lds=163840
.amdgcn_target "amdgcn-amd-amdhsa--gfx950"
.text
.globl recurrent_scan__sliding_block_cached__swiglu_ffn__decode_kernel
.p2align 8
.type recurrent_scan__sliding_block_cached__swiglu_ffn__decode_kernel,@function
recurrent_scan__sliding_block_cached__swiglu_ffn__decode_kernel:
    s_cmp_ge_u32 s2, 256
    s_cbranch_scc1 L_end
    s_load_dwordx16 s[4:19], s[0:1], 0
    s_load_dwordx8 s[20:27], s[0:1], 64
    v_lshrrev_b32 v1, 6, v0
    v_and_b32 v0, 63, v0
    s_and_b32 s28, s2, 7
    v_readfirstlane_b32 s32, v1
    s_lshr_b32 s29, s2, 3
    s_lshr_b32 s30, s29, 2
    s_and_b32 s31, s29, 3
    s_bfe_u32 s33, s29, 0x10001
    s_cmp_ge_u32 s29, 16
    s_cselect_b32 s33, 2, s33
    s_cmp_eq_u32 s28, 7
    s_cselect_b32 s33, 3, s33
    s_bfe_u32 s68, s29, 0x20002
    s_lshl_b32 s69, s28, 2
    s_add_u32 s68, s68, s69
    s_and_b32 s69, s29, 3
    s_mov_b32 s70, 0
    s_getreg_b32 s74, hwreg(HW_REG_XCC_ID)
    s_and_b32 s74, s74, 15
    s_lshl_b32 s74, s74, 28
    s_cmp_lt_u32 s33, 2
    s_cselect_b32 s35, 48, 16
    s_cselect_b32 s38, 48, 0x60
    s_add_u32 s36, s35, 64
    s_cmp_eq_u32 s33, 2
    s_cselect_b32 s36, 0x60, s36
    s_add_u32 s37, s36, 0x50
    s_mov_b32 s55, s37
    s_mul_i32 s39, s2, 0x9e3779b1
    s_lshr_b32 s39, s39, 26
    v_mov_b32 v3, 161792
    v_mov_b32 v5, 1
    s_mov_b32 s58, 0x00ff00ff
    s_mov_b32 s59, 0x00ff00ff
    s_cmp_lt_u32 s32, 4
    s_cbranch_scc1 L_cwave
    s_cmp_eq_u32 s32, 5
    s_cbranch_scc1 L_fwave
    s_cmp_eq_u32 s32, 6
    s_cbranch_scc1 L_swave
L_loader:
    s_setprio 3
    v_mov_b32 v20, 0
    v_lshlrev_b32 v21, 2, v0
    v_add_u32 v21, 161792, v21
    ds_write_b32 v21, v20
    v_lshrrev_b32 v6, 4, v0
    v_lshrrev_b32 v7, 3, v0
    v_and_b32 v8, 1, v0
    v_lshlrev_b32 v8, 4, v8
    v_bfe_u32 v9, v0, 1, 2
    v_xor_b32 v9, v9, v6
    v_lshl_or_b32 v9, v9, 5, v8
    v_lshl_add_u32 v10, v7, 13, v9
    s_mov_b32 s47, -23
    s_waitcnt lgkmcnt(0)
    s_mov_b32 s40, s10
    s_and_b32 s41, s11, 0xffff
    s_mov_b32 s42, 4194304
    s_mov_b32 s43, 0x20000
    s_lshr_b32 s44, s29, 3
    s_lshl_b32 s44, s44, 20
    s_lshl_b32 s48, s28, 10
    s_add_u32 s44, s44, s48
    s_and_b32 s48, s29, 7
    s_lshl_b32 s48, s48, 7
    s_add_u32 s44, s44, s48
    s_mov_b32 s45, 131072
    s_mov_b32 s46, 4
SEG_1:
    s_mov_b32 m0, s45
    s_add_u32 s47, s47, 1
    buffer_load_dwordx4 v10, s[40:43], s44 offen nt lds
    s_add_u32 s45, s45, 1024
    s_add_u32 s44, s44, 65536
    s_mov_b32 m0, s45
    s_add_u32 s47, s47, 1
    buffer_load_dwordx4 v10, s[40:43], s44 offen nt lds
    s_add_u32 s45, s45, 1024
    s_add_u32 s44, s44, 65536
    s_mov_b32 m0, s45
    s_add_u32 s47, s47, 1
    buffer_load_dwordx4 v10, s[40:43], s44 offen nt lds
    s_add_u32 s45, s45, 1024
    s_add_u32 s44, s44, 65536
    s_mov_b32 m0, s45
    s_add_u32 s47, s47, 1
    buffer_load_dwordx4 v10, s[40:43], s44 offen nt lds
    s_add_u32 s45, s45, 1024
    s_add_u32 s44, s44, 65536
    s_sub_u32 s46, s46, 1
    s_cmp_lg_u32 s46, 0
    s_cbranch_scc1 SEG_1
    s_barrier
    v_and_b32 v11, 15, v0
    v_xor_b32 v11, v11, v6
    v_lshlrev_b32 v11, 4, v11
    v_lshl_add_u32 v11, v6, 8, v11
    s_and_b32 s48, s39, 3
    s_lshl_b32 s48, s48, 6
    v_xor_b32 v11, s48, v11
    v_xor_b32 v12, 64, v11
    v_xor_b32 v13, 0x80, v11
    v_xor_b32 v14, 0xc0, v11
    v_bfe_u32 v15, v0, 1, 3
    v_xor_b32 v15, v15, v6
    v_lshl_or_b32 v15, v15, 5, v8
    v_lshl_add_u32 v16, v6, 8, v15
    s_and_b32 s48, s39, 1
    s_lshl_b32 s48, s48, 7
    v_xor_b32 v16, s48, v16
    v_xor_b32 v17, 0x80, v16
    v_lshl_add_u32 v18, v6, 10, v15
    v_xor_b32 v19, 0x80, v18
    v_lshl_add_u32 v22, v7, 10, v9
    s_movk_i32 s48, 3584
    v_mul_lo_u32 v23, v7, s48
    v_add_u32 v23, v23, v9
    s_lshl_b32 s50, s30, 3
    s_add_u32 s50, s50, s28
    s_lshl_b32 s50, s50, 20
    s_lshl_b32 s48, s31, 16
    s_add_u32 s50, s50, s48
    s_add_u32 s50, s50, 786432
    s_cmp_lt_u32 s33, 2
    s_cbranch_scc0 L_noGU
    s_cmp_eq_u32 s33, 0
    s_cselect_b32 s52, s16, s18
    s_cselect_b32 s53, s17, s19
    s_add_u32 s47, s47, -3
    s_mov_b32 s40, s52
    s_and_b32 s41, s53, 0xffff
    s_mov_b32 s42, 1835008
    s_mov_b32 s43, 0x20000
    s_and_b32 s44, s69, 1
    s_mul_i32 s44, s44, 917504
    s_lshl_b32 s48, s68, 7
    s_add_u32 s44, s44, s48
    s_mov_b32 s45, 98304
    s_mov_b32 s46, 8
SEG_2:
    s_waitcnt vmcnt(26)
    v_mov_b32 v20, s47
    ds_write_b32 v3, v20 offset:0
    s_mov_b32 m0, s45
    s_add_u32 s47, s47, 1
    buffer_load_dwordx4 v23, s[40:43], s44 offen nt lds
    s_add_u32 s45, s45, 1024
    s_add_u32 s44, s44, 28672
    s_waitcnt vmcnt(26)
    v_mov_b32 v20, s47
    ds_write_b32 v3, v20 offset:0
    s_mov_b32 m0, s45
    s_add_u32 s47, s47, 1
    buffer_load_dwordx4 v23, s[40:43], s44 offen nt lds
    s_add_u32 s45, s45, 1024
    s_add_u32 s44, s44, 28672
    s_waitcnt vmcnt(26)
    v_mov_b32 v20, s47
    ds_write_b32 v3, v20 offset:0
    s_mov_b32 m0, s45
    s_add_u32 s47, s47, 1
    buffer_load_dwordx4 v23, s[40:43], s44 offen nt lds
    s_add_u32 s45, s45, 1024
    s_add_u32 s44, s44, 28672
    s_waitcnt vmcnt(26)
    v_mov_b32 v20, s47
    ds_write_b32 v3, v20 offset:0
    s_mov_b32 m0, s45
    s_add_u32 s47, s47, 1
    buffer_load_dwordx4 v23, s[40:43], s44 offen nt lds
    s_add_u32 s45, s45, 1024
    s_add_u32 s44, s44, 28672
    s_sub_u32 s46, s46, 1
    s_cmp_lg_u32 s46, 0
    s_cbranch_scc1 SEG_2
    s_mov_b32 s40, s6
    s_and_b32 s41, s7, 0xffff
    s_mov_b32 s42, 67108864
    s_mov_b32 s43, 0x20000
    s_mov_b32 s44, s50
    s_lshl_b32 s45, s39, 10
    s_mov_b32 s49, 0
    s_mov_b32 s46, 16
SEG_3:
    s_xor_b32 s48, s49, s45
    s_add_u32 s54, s44, s48
    s_waitcnt vmcnt(26)
    v_mov_b32 v20, s47
    ds_write_b32 v3, v20 offset:0
    s_add_u32 m0, s48, 0
    s_add_u32 s47, s47, 1
    buffer_load_dwordx4 v11, s[40:43], s54 offen nt lds
    s_add_u32 s49, s49, 1024
    s_xor_b32 s48, s49, s45
    s_add_u32 s54, s44, s48
    s_waitcnt vmcnt(26)
    v_mov_b32 v20, s47
    ds_write_b32 v3, v20 offset:0
    s_add_u32 m0, s48, 0
    s_add_u32 s47, s47, 1
    buffer_load_dwordx4 v12, s[40:43], s54 offen nt lds
    s_add_u32 s49, s49, 1024
    s_xor_b32 s48, s49, s45
    s_add_u32 s54, s44, s48
    s_waitcnt vmcnt(26)
    v_mov_b32 v20, s47
    ds_write_b32 v3, v20 offset:0
    s_add_u32 m0, s48, 0
    s_add_u32 s47, s47, 1
    buffer_load_dwordx4 v13, s[40:43], s54 offen nt lds
    s_add_u32 s49, s49, 1024
    s_xor_b32 s48, s49, s45
    s_add_u32 s54, s44, s48
    s_waitcnt vmcnt(26)
    v_mov_b32 v20, s47
    ds_write_b32 v3, v20 offset:0
    s_add_u32 m0, s48, 0
    s_add_u32 s47, s47, 1
    buffer_load_dwordx4 v14, s[40:43], s54 offen nt lds
    s_add_u32 s49, s49, 1024
    s_sub_u32 s46, s46, 1
    s_cmp_lg_u32 s46, 0
    s_cbranch_scc1 SEG_3
    s_mov_b32 s61, 0
WL_4:
    ds_read_b32 v4, v3 offset:24
    s_waitcnt lgkmcnt(0)
    v_readfirstlane_b32 s60, v4
    s_add_u32 s61, s61, 1
    s_cmp_ge_i32 s60, 1
    s_cbranch_scc1 WD_5
    s_sleep 1
    s_cmp_lt_u32 s61, 1048576
    s_cbranch_scc1 WL_4
WD_5:
    s_mov_b32 s40, s8
    s_and_b32 s41, s9, 0xffff
    s_mov_b32 s42, 67108864
    s_mov_b32 s43, 0x20000
    s_mov_b32 s44, s50
    s_lshl_b32 s45, s39, 10
    s_mov_b32 s49, 0
    s_mov_b32 s46, 8
SEG_6:
    s_xor_b32 s48, s49, s45
    s_add_u32 s54, s44, s48
    s_waitcnt vmcnt(26)
    v_mov_b32 v20, s47
    ds_write_b32 v3, v20 offset:0
    s_add_u32 m0, s48, 65536
    s_add_u32 s47, s47, 1
    buffer_load_dwordx4 v16, s[40:43], s54 offen nt lds
    s_add_u32 s49, s49, 1024
    s_xor_b32 s48, s49, s45
    s_add_u32 s54, s44, s48
    s_waitcnt vmcnt(26)
    v_mov_b32 v20, s47
    ds_write_b32 v3, v20 offset:0
    s_add_u32 m0, s48, 65536
    s_add_u32 s47, s47, 1
    buffer_load_dwordx4 v17, s[40:43], s54 offen nt lds
    s_add_u32 s49, s49, 1024
    s_xor_b32 s48, s49, s45
    s_add_u32 s54, s44, s48
    s_waitcnt vmcnt(26)
    v_mov_b32 v20, s47
    ds_write_b32 v3, v20 offset:0
    s_add_u32 m0, s48, 65536
    s_add_u32 s47, s47, 1
    buffer_load_dwordx4 v16, s[40:43], s54 offen nt lds
    s_add_u32 s49, s49, 1024
    s_xor_b32 s48, s49, s45
    s_add_u32 s54, s44, s48
    s_waitcnt vmcnt(26)
    v_mov_b32 v20, s47
    ds_write_b32 v3, v20 offset:0
    s_add_u32 m0, s48, 65536
    s_add_u32 s47, s47, 1
    buffer_load_dwordx4 v17, s[40:43], s54 offen nt lds
    s_add_u32 s49, s49, 1024
    s_sub_u32 s46, s46, 1
    s_cmp_lg_u32 s46, 0
    s_cbranch_scc1 SEG_6
    s_add_u32 s47, s47, 3
    s_branch L_vtail
L_noGU:
    s_mov_b32 s40, s6
    s_and_b32 s41, s7, 0xffff
    s_mov_b32 s42, 67108864
    s_mov_b32 s43, 0x20000
    s_mov_b32 s44, s50
    s_lshl_b32 s45, s39, 10
    s_mov_b32 s49, 0
    s_mov_b32 s46, 16
SEG_7:
    s_xor_b32 s48, s49, s45
    s_add_u32 s54, s44, s48
    s_waitcnt vmcnt(23)
    v_mov_b32 v20, s47
    ds_write_b32 v3, v20 offset:0
    s_add_u32 m0, s48, 0
    s_add_u32 s47, s47, 1
    buffer_load_dwordx4 v11, s[40:43], s54 offen nt lds
    s_add_u32 s49, s49, 1024
    s_xor_b32 s48, s49, s45
    s_add_u32 s54, s44, s48
    s_waitcnt vmcnt(23)
    v_mov_b32 v20, s47
    ds_write_b32 v3, v20 offset:0
    s_add_u32 m0, s48, 0
    s_add_u32 s47, s47, 1
    buffer_load_dwordx4 v12, s[40:43], s54 offen nt lds
    s_add_u32 s49, s49, 1024
    s_xor_b32 s48, s49, s45
    s_add_u32 s54, s44, s48
    s_waitcnt vmcnt(23)
    v_mov_b32 v20, s47
    ds_write_b32 v3, v20 offset:0
    s_add_u32 m0, s48, 0
    s_add_u32 s47, s47, 1
    buffer_load_dwordx4 v13, s[40:43], s54 offen nt lds
    s_add_u32 s49, s49, 1024
    s_xor_b32 s48, s49, s45
    s_add_u32 s54, s44, s48
    s_waitcnt vmcnt(23)
    v_mov_b32 v20, s47
    ds_write_b32 v3, v20 offset:0
    s_add_u32 m0, s48, 0
    s_add_u32 s47, s47, 1
    buffer_load_dwordx4 v14, s[40:43], s54 offen nt lds
    s_add_u32 s49, s49, 1024
    s_sub_u32 s46, s46, 1
    s_cmp_lg_u32 s46, 0
    s_cbranch_scc1 SEG_7
    s_cmp_eq_u32 s33, 2
    s_cbranch_scc0 L_noD
    s_mov_b32 s61, 0
WL_8:
    ds_read_b32 v4, v3 offset:8
    s_waitcnt lgkmcnt(0)
    v_readfirstlane_b32 s60, v4
    s_add_u32 s61, s61, 1
    s_cmp_ge_i32 s60, 2
    s_cbranch_scc1 WD_9
    s_sleep 1
    s_cmp_lt_u32 s61, 1048576
    s_cbranch_scc1 WL_8
WD_9:
    s_mov_b32 s40, s20
    s_and_b32 s41, s21, 0xffff
    s_mov_b32 s42, 1835008
    s_mov_b32 s43, 0x20000
    s_lshl_b32 s44, s68, 16
    s_lshl_b32 s48, s69, 8
    s_add_u32 s44, s44, s48
    s_mov_b32 s45, 131072
    s_mov_b32 s46, 4
SEG_10:
    s_waitcnt vmcnt(23)
    v_mov_b32 v20, s47
    ds_write_b32 v3, v20 offset:0
    s_mov_b32 m0, s45
    s_add_u32 s47, s47, 1
    buffer_load_dwordx4 v18, s[40:43], s44 offen nt lds
    s_add_u32 s45, s45, 1024
    s_add_u32 s44, s44, 4096
    s_waitcnt vmcnt(23)
    v_mov_b32 v20, s47
    ds_write_b32 v3, v20 offset:0
    s_mov_b32 m0, s45
    s_add_u32 s47, s47, 1
    buffer_load_dwordx4 v19, s[40:43], s44 offen nt lds
    s_add_u32 s45, s45, 1024
    s_add_u32 s44, s44, 4096
    s_waitcnt vmcnt(23)
    v_mov_b32 v20, s47
    ds_write_b32 v3, v20 offset:0
    s_mov_b32 m0, s45
    s_add_u32 s47, s47, 1
    buffer_load_dwordx4 v18, s[40:43], s44 offen nt lds
    s_add_u32 s45, s45, 1024
    s_add_u32 s44, s44, 4096
    s_waitcnt vmcnt(23)
    v_mov_b32 v20, s47
    ds_write_b32 v3, v20 offset:0
    s_mov_b32 m0, s45
    s_add_u32 s47, s47, 1
    buffer_load_dwordx4 v19, s[40:43], s44 offen nt lds
    s_add_u32 s45, s45, 1024
    s_add_u32 s44, s44, 4096
    s_sub_u32 s46, s46, 1
    s_cmp_lg_u32 s46, 0
    s_cbranch_scc1 SEG_10
L_noD:
    s_mov_b32 s40, s8
    s_and_b32 s41, s9, 0xffff
    s_mov_b32 s42, 67108864
    s_mov_b32 s43, 0x20000
    s_mov_b32 s44, s50
    s_lshl_b32 s45, s39, 10
    s_mov_b32 s49, 0
    s_mov_b32 s46, 8
SEG_11:
    s_xor_b32 s48, s49, s45
    s_add_u32 s54, s44, s48
    s_waitcnt vmcnt(23)
    v_mov_b32 v20, s47
    ds_write_b32 v3, v20 offset:0
    s_add_u32 m0, s48, 65536
    s_add_u32 s47, s47, 1
    buffer_load_dwordx4 v16, s[40:43], s54 offen nt lds
    s_add_u32 s49, s49, 1024
    s_xor_b32 s48, s49, s45
    s_add_u32 s54, s44, s48
    s_waitcnt vmcnt(23)
    v_mov_b32 v20, s47
    ds_write_b32 v3, v20 offset:0
    s_add_u32 m0, s48, 65536
    s_add_u32 s47, s47, 1
    buffer_load_dwordx4 v17, s[40:43], s54 offen nt lds
    s_add_u32 s49, s49, 1024
    s_xor_b32 s48, s49, s45
    s_add_u32 s54, s44, s48
    s_waitcnt vmcnt(23)
    v_mov_b32 v20, s47
    ds_write_b32 v3, v20 offset:0
    s_add_u32 m0, s48, 65536
    s_add_u32 s47, s47, 1
    buffer_load_dwordx4 v16, s[40:43], s54 offen nt lds
    s_add_u32 s49, s49, 1024
    s_xor_b32 s48, s49, s45
    s_add_u32 s54, s44, s48
    s_waitcnt vmcnt(23)
    v_mov_b32 v20, s47
    ds_write_b32 v3, v20 offset:0
    s_add_u32 m0, s48, 65536
    s_add_u32 s47, s47, 1
    buffer_load_dwordx4 v17, s[40:43], s54 offen nt lds
    s_add_u32 s49, s49, 1024
    s_sub_u32 s46, s46, 1
    s_cmp_lg_u32 s46, 0
    s_cbranch_scc1 SEG_11
L_vtail:
    s_mov_b32 s40, s8
    s_and_b32 s41, s9, 0xffff
    s_mov_b32 s42, 67108864
    s_mov_b32 s43, 0x20000
    s_mov_b32 s44, s50
    s_lshl_b32 s45, s39, 10
    s_mov_b32 s49, 32768
    s_mov_b32 s46, 8
SEG_12:
    s_xor_b32 s48, s49, s45
    s_add_u32 s54, s44, s48
    s_waitcnt vmcnt(23)
    v_mov_b32 v20, s47
    ds_write_b32 v3, v20 offset:0
    s_add_u32 m0, s48, 65536
    s_add_u32 s47, s47, 1
    buffer_load_dwordx4 v16, s[40:43], s54 offen nt lds
    s_add_u32 s49, s49, 1024
    s_xor_b32 s48, s49, s45
    s_add_u32 s54, s44, s48
    s_waitcnt vmcnt(23)
    v_mov_b32 v20, s47
    ds_write_b32 v3, v20 offset:0
    s_add_u32 m0, s48, 65536
    s_add_u32 s47, s47, 1
    buffer_load_dwordx4 v17, s[40:43], s54 offen nt lds
    s_add_u32 s49, s49, 1024
    s_xor_b32 s48, s49, s45
    s_add_u32 s54, s44, s48
    s_waitcnt vmcnt(23)
    v_mov_b32 v20, s47
    ds_write_b32 v3, v20 offset:0
    s_add_u32 m0, s48, 65536
    s_add_u32 s47, s47, 1
    buffer_load_dwordx4 v16, s[40:43], s54 offen nt lds
    s_add_u32 s49, s49, 1024
    s_xor_b32 s48, s49, s45
    s_add_u32 s54, s44, s48
    s_waitcnt vmcnt(23)
    v_mov_b32 v20, s47
    ds_write_b32 v3, v20 offset:0
    s_add_u32 m0, s48, 65536
    s_add_u32 s47, s47, 1
    buffer_load_dwordx4 v17, s[40:43], s54 offen nt lds
    s_add_u32 s49, s49, 1024
    s_sub_u32 s46, s46, 1
    s_cmp_lg_u32 s46, 0
    s_cbranch_scc1 SEG_12
    s_mov_b32 s61, 0
WL_13:
    ds_read_b32 v4, v3 offset:20
    s_waitcnt lgkmcnt(0)
    v_readfirstlane_b32 s60, v4
    s_add_u32 s61, s61, 1
    s_cmp_ge_i32 s60, 4
    s_cbranch_scc1 WD_14
    s_cmp_lg_u32 s70, 0
    s_cbranch_scc1 QR_15
    s_cmp_lt_u32 s61, 24
    s_cbranch_scc1 QR_15
    s_mov_b32 s70, 1
    s_mov_b32 s73, s61
    s_mov_b32 s61, 0
WL_16:
    ds_read_b32 v4, v3 offset:8
    s_waitcnt lgkmcnt(0)
    v_readfirstlane_b32 s60, v4
    s_add_u32 s61, s61, 1
    s_cmp_ge_i32 s60, 2
    s_cbranch_scc1 WD_17
    s_sleep 1
    s_cmp_lt_u32 s61, 1048576
    s_cbranch_scc1 WL_16
WD_17:
    s_mov_b32 s61, s73
    v_lshlrev_b32 v24, 3, v0
    v_add_u32 v24, 162048, v24
    v_lshlrev_b32 v25, 2, v0
    v_add_u32 v25, 162048, v25
    ds_read_b32 v29, v3 offset:192
    ds_read_b64 v[26:27], v24
    ds_read_b32 v36, v25 offset:512
    ds_read_b64 v[38:39], v24 offset:768
    ds_read_b32 v37, v25 offset:1280
    s_waitcnt lgkmcnt(0)
    v_mov_b32 v28, v26
    v_mov_b32 v30, v27
    v_xor_b32 v31, s74, v29
    v_mov_b32 v32, v38
    v_mov_b32 v33, v29
    v_mov_b32 v34, v39
    v_xor_b32 v35, s74, v29
    global_store_dwordx4 v36, v[28:31], s[26:27] sc1
    global_store_dwordx4 v37, v[32:35], s[26:27] sc1
QR_15:
    s_sleep 1
    s_cmp_lt_u32 s61, 1048576
    s_cbranch_scc1 WL_13
WD_14:
    s_mov_b32 s40, s12
    s_and_b32 s41, s13, 0xffff
    s_mov_b32 s42, 4194304
    s_mov_b32 s43, 0x20000
    s_lshl_b32 s44, s28, 2
    s_lshr_b32 s48, s29, 3
    s_add_u32 s44, s44, s48
    s_lshl_b32 s44, s44, 17
    s_and_b32 s48, s29, 7
    s_lshl_b32 s48, s48, 7
    s_add_u32 s44, s44, s48
    s_mov_b32 s45, 0
    s_mov_b32 s46, 4
SEG_18:
    s_waitcnt vmcnt(23)
    v_mov_b32 v20, s47
    ds_write_b32 v3, v20 offset:0
    s_mov_b32 m0, s45
    s_add_u32 s47, s47, 1
    buffer_load_dwordx4 v22, s[40:43], s44 offen nt lds
    s_add_u32 s45, s45, 1024
    s_add_u32 s44, s44, 8192
    s_waitcnt vmcnt(23)
    v_mov_b32 v20, s47
    ds_write_b32 v3, v20 offset:0
    s_mov_b32 m0, s45
    s_add_u32 s47, s47, 1
    buffer_load_dwordx4 v22, s[40:43], s44 offen nt lds
    s_add_u32 s45, s45, 1024
    s_add_u32 s44, s44, 8192
    s_waitcnt vmcnt(23)
    v_mov_b32 v20, s47
    ds_write_b32 v3, v20 offset:0
    s_mov_b32 m0, s45
    s_add_u32 s47, s47, 1
    buffer_load_dwordx4 v22, s[40:43], s44 offen nt lds
    s_add_u32 s45, s45, 1024
    s_add_u32 s44, s44, 8192
    s_waitcnt vmcnt(23)
    v_mov_b32 v20, s47
    ds_write_b32 v3, v20 offset:0
    s_mov_b32 m0, s45
    s_add_u32 s47, s47, 1
    buffer_load_dwordx4 v22, s[40:43], s44 offen nt lds
    s_add_u32 s45, s45, 1024
    s_add_u32 s44, s44, 8192
    s_sub_u32 s46, s46, 1
    s_cmp_lg_u32 s46, 0
    s_cbranch_scc1 SEG_18
    s_waitcnt vmcnt(16)
    s_sub_u32 s48, s55, 16
    v_mov_b32 v20, s48
    ds_write_b32 v3, v20 offset:0
    s_waitcnt vmcnt(8)
    s_sub_u32 s48, s55, 8
    v_mov_b32 v20, s48
    ds_write_b32 v3, v20 offset:0
    s_waitcnt vmcnt(0)
    s_sub_u32 s48, s55, 0
    v_mov_b32 v20, s48
    ds_write_b32 v3, v20 offset:0
    s_cmp_lg_u32 s70, 0
    s_cbranch_scc1 QR_19
    ds_read_b32 v4, v3 offset:36
    s_waitcnt lgkmcnt(0)
    v_readfirstlane_b32 s76, v4
    s_cmp_eq_u32 s76, 0
    s_cbranch_scc1 QR_19
    s_mov_b32 s70, 1
    s_mov_b32 s73, s61
    s_mov_b32 s61, 0
WL_20:
    ds_read_b32 v4, v3 offset:8
    s_waitcnt lgkmcnt(0)
    v_readfirstlane_b32 s60, v4
    s_add_u32 s61, s61, 1
    s_cmp_ge_i32 s60, 2
    s_cbranch_scc1 WD_21
    s_sleep 1
    s_cmp_lt_u32 s61, 1048576
    s_cbranch_scc1 WL_20
WD_21:
    s_mov_b32 s61, s73
    v_lshlrev_b32 v24, 3, v0
    v_add_u32 v24, 162048, v24
    v_lshlrev_b32 v25, 2, v0
    v_add_u32 v25, 162048, v25
    ds_read_b32 v29, v3 offset:192
    ds_read_b64 v[26:27], v24
    ds_read_b32 v36, v25 offset:512
    ds_read_b64 v[38:39], v24 offset:768
    ds_read_b32 v37, v25 offset:1280
    s_waitcnt lgkmcnt(0)
    v_mov_b32 v28, v26
    v_mov_b32 v30, v27
    v_xor_b32 v31, s74, v29
    v_mov_b32 v32, v38
    v_mov_b32 v33, v29
    v_mov_b32 v34, v39
    v_xor_b32 v35, s74, v29
    global_store_dwordx4 v36, v[28:31], s[26:27] sc1
    global_store_dwordx4 v37, v[32:35], s[26:27] sc1
QR_19:
    s_endpgm
L_cwave:
    s_lshl_b32 s48, s32, 11
    v_lshlrev_b32 v6, 4, v0
    v_add_u32 v6, s48, v6
    v_and_b32 v1, 15, v0
    v_lshrrev_b32 v2, 4, v0
    s_waitcnt lgkmcnt(0)
    global_load_dwordx4 v[8:11], v6, s[4:5]
    global_load_dwordx4 v[12:15], v6, s[4:5] offset:1024
    s_load_dword s34, s[26:27], 0
    s_barrier
    v_lshrrev_b32 v6, 2, v0
    v_lshlrev_b32 v6, 9, v6
    v_and_b32 v7, 1, v0
    v_lshl_add_u32 v6, v7, 8, v6
    v_bfe_u32 v7, v0, 1, 1
    v_lshl_add_u32 v6, v7, 3, v6
    s_lshl_b32 s48, s32, 5
    s_add_u32 s48, s48, 147456
    v_add_u32 v6, s48, v6
    v_lshrrev_b32 v48, 2, v0
    v_and_b32 v49, 3, v0
    v_lshlrev_b32 v49, 3, v49
    v_bfe_u32 v50, v0, 3, 2
    v_lshl_or_b32 v50, v50, 5, v49
    v_lshl_add_u32 v50, v48, 7, v50
    v_and_b32 v51, 7, v48
    v_lshl_or_b32 v51, v51, 5, v49
    v_lshl_add_u32 v51, v48, 8, v51
    v_and_b32 v112, 7, v0
    v_bfe_u32 v113, v0, 3, 1
    v_and_b32 v114, 3, v0
    v_lshlrev_b32 v52, 4, v112
    v_lshl_add_u32 v52, v2, 7, v52
    s_lshr_b32 s49, s29, 3
    s_lshl_b32 s48, s49, 11
    s_add_u32 s48, s48, 147456
    v_add_u32 v52, s48, v52
    s_lshl_b32 s48, s32, 6
    s_and_b32 s48, s48, 0x60
    v_xor_b32 v53, s48, v50
    v_add_u32 v53, 131072, v53
    v_xor_b32 v115, 32, v53
    s_lshl_b32 s48, s28, 5
    s_add_u32 s48, s48, s49
    s_lshl_b32 s48, s48, 11
    s_and_b32 s50, s29, 7
    s_lshl_b32 s50, s50, 8
    s_add_u32 s48, s48, s50
    s_lshl_b32 s50, s32, 7
    s_add_u32 s48, s48, s50
    s_add_u32 s48, s48, 65536
    v_lshlrev_b32 v54, 13, v112
    v_lshl_add_u32 v54, v113, 6, v54
    v_lshl_add_u32 v54, v2, 4, v54
    v_add_u32 v54, s48, v54
    s_lshl_b32 s48, s28, 3
    s_add_u32 s48, s48, s30
    s_lshl_b32 s48, s48, 13
    s_add_u32 s48, s48, s50
    s_add_u32 s48, s48, 65536
    v_lshrrev_b32 v55, 2, v1
    v_lshlrev_b32 v55, 11, v55
    v_lshl_add_u32 v55, v114, 9, v55
    v_lshl_add_u32 v55, v2, 5, v55
    v_add_u32 v55, s48, v55
    s_waitcnt vmcnt(0)
    v_lshlrev_b32 v16, 16, v8
    v_and_b32 v17, 0xffff0000, v8
    v_lshlrev_b32 v18, 16, v9
    v_and_b32 v19, 0xffff0000, v9
    v_lshlrev_b32 v20, 16, v10
    v_and_b32 v21, 0xffff0000, v10
    v_lshlrev_b32 v22, 16, v11
    v_and_b32 v23, 0xffff0000, v11
    v_lshlrev_b32 v24, 16, v12
    v_and_b32 v25, 0xffff0000, v12
    v_lshlrev_b32 v26, 16, v13
    v_and_b32 v27, 0xffff0000, v13
    v_lshlrev_b32 v28, 16, v14
    v_and_b32 v29, 0xffff0000, v14
    v_lshlrev_b32 v30, 16, v15
    v_and_b32 v31, 0xffff0000, v15
    v_add_f32 v32, v16, v17
    v_add_f32 v34, v18, v19
    v_add_f32 v35, v20, v21
    v_add_f32 v36, v22, v23
    v_add_f32 v32, v32, v34
    v_add_f32 v35, v35, v36
    v_add_f32 v32, v32, v35
    v_add_f32 v33, v24, v25
    v_add_f32 v34, v26, v27
    v_add_f32 v35, v28, v29
    v_add_f32 v36, v30, v31
    v_add_f32 v33, v33, v34
    v_add_f32 v35, v35, v36
    v_add_f32 v33, v33, v35
    s_nop 1
    v_add_f32_dpp v32, v32, v32 row_ror:8 row_mask:0xf bank_mask:0xf
    v_add_f32_dpp v33, v33, v33 row_ror:8 row_mask:0xf bank_mask:0xf
    s_nop 1
    v_add_f32_dpp v32, v32, v32 row_ror:4 row_mask:0xf bank_mask:0xf
    v_add_f32_dpp v33, v33, v33 row_ror:4 row_mask:0xf bank_mask:0xf
    s_nop 1
    v_add_f32_dpp v32, v32, v32 row_ror:2 row_mask:0xf bank_mask:0xf
    v_add_f32_dpp v33, v33, v33 row_ror:2 row_mask:0xf bank_mask:0xf
    s_nop 1
    v_add_f32_dpp v32, v32, v32 row_ror:1 row_mask:0xf bank_mask:0xf
    v_add_f32_dpp v33, v33, v33 row_ror:1 row_mask:0xf bank_mask:0xf
    v_mov_b32 v34, v32
    v_mov_b32 v35, v33
    s_nop 1
    v_permlane16_swap_b32 v32, v34
    v_permlane16_swap_b32 v33, v35
    s_nop 0
    v_add_f32 v32, v32, v34
    v_add_f32 v33, v33, v35
    v_mov_b32 v34, v32
    v_mov_b32 v35, v33
    s_nop 1
    v_permlane32_swap_b32 v32, v34
    v_permlane32_swap_b32 v33, v35
    s_nop 0
    v_add_f32 v32, v32, v34
    v_add_f32 v33, v33, v35
    v_mul_f32 v32, 0x3b000000, v32
    v_mul_f32 v33, 0x3b000000, v33
    v_sub_f32 v38, v16, v32
    v_mul_f32 v36, v38, v38
    v_sub_f32 v38, v17, v32
    v_fmac_f32 v36, v38, v38
    v_sub_f32 v38, v18, v32
    v_fmac_f32 v36, v38, v38
    v_sub_f32 v38, v19, v32
    v_fmac_f32 v36, v38, v38
    v_sub_f32 v38, v20, v32
    v_fmac_f32 v36, v38, v38
    v_sub_f32 v38, v21, v32
    v_fmac_f32 v36, v38, v38
    v_sub_f32 v38, v22, v32
    v_fmac_f32 v36, v38, v38
    v_sub_f32 v38, v23, v32
    v_fmac_f32 v36, v38, v38
    v_sub_f32 v38, v24, v33
    v_mul_f32 v37, v38, v38
    v_sub_f32 v38, v25, v33
    v_fmac_f32 v37, v38, v38
    v_sub_f32 v38, v26, v33
    v_fmac_f32 v37, v38, v38
    v_sub_f32 v38, v27, v33
    v_fmac_f32 v37, v38, v38
    v_sub_f32 v38, v28, v33
    v_fmac_f32 v37, v38, v38
    v_sub_f32 v38, v29, v33
    v_fmac_f32 v37, v38, v38
    v_sub_f32 v38, v30, v33
    v_fmac_f32 v37, v38, v38
    v_sub_f32 v38, v31, v33
    v_fmac_f32 v37, v38, v38
    s_nop 1
    v_add_f32_dpp v36, v36, v36 row_ror:8 row_mask:0xf bank_mask:0xf
    v_add_f32_dpp v37, v37, v37 row_ror:8 row_mask:0xf bank_mask:0xf
    s_nop 1
    v_add_f32_dpp v36, v36, v36 row_ror:4 row_mask:0xf bank_mask:0xf
    v_add_f32_dpp v37, v37, v37 row_ror:4 row_mask:0xf bank_mask:0xf
    s_nop 1
    v_add_f32_dpp v36, v36, v36 row_ror:2 row_mask:0xf bank_mask:0xf
    v_add_f32_dpp v37, v37, v37 row_ror:2 row_mask:0xf bank_mask:0xf
    s_nop 1
    v_add_f32_dpp v36, v36, v36 row_ror:1 row_mask:0xf bank_mask:0xf
    v_add_f32_dpp v37, v37, v37 row_ror:1 row_mask:0xf bank_mask:0xf
    v_mov_b32 v34, v36
    v_mov_b32 v35, v37
    s_nop 1
    v_permlane16_swap_b32 v36, v34
    v_permlane16_swap_b32 v37, v35
    s_nop 0
    v_add_f32 v36, v36, v34
    v_add_f32 v37, v37, v35
    v_mov_b32 v34, v36
    v_mov_b32 v35, v37
    s_nop 1
    v_permlane32_swap_b32 v36, v34
    v_permlane32_swap_b32 v37, v35
    s_nop 0
    v_add_f32 v36, v36, v34
    v_add_f32 v37, v37, v35
    v_mul_f32 v36, 0x3b000000, v36
    v_mul_f32 v37, 0x3b000000, v37
    v_cvt_pk_bf16_f32 v38, v32, v36
    v_lshlrev_b32 v32, 16, v38
    v_and_b32 v36, 0xffff0000, v38
    v_add_f32 v36, 0x3727c5ac, v36
    v_cvt_pk_bf16_f32 v36, v36, v36
    v_lshlrev_b32 v36, 16, v36
    v_sqrt_f32 v36, v36
    s_nop 0
    v_cvt_pk_bf16_f32 v36, v36, v36
    v_lshlrev_b32 v36, 16, v36
    v_rcp_f32 v36, v36
    s_nop 0
    v_cvt_pk_bf16_f32 v38, v33, v37
    v_lshlrev_b32 v33, 16, v38
    v_and_b32 v37, 0xffff0000, v38
    v_add_f32 v37, 0x3727c5ac, v37
    v_cvt_pk_bf16_f32 v37, v37, v37
    v_lshlrev_b32 v37, 16, v37
    v_sqrt_f32 v37, v37
    s_nop 0
    v_cvt_pk_bf16_f32 v37, v37, v37
    v_lshlrev_b32 v37, 16, v37
    v_rcp_f32 v37, v37
    s_nop 0
    v_sub_f32 v38, v16, v32
    v_sub_f32 v39, v17, v32
    v_cvt_pk_bf16_f32 v38, v38, v39
    v_and_b32 v39, 0xffff0000, v38
    v_lshlrev_b32 v38, 16, v38
    v_mul_f32 v38, v38, v36
    v_mul_f32 v39, v39, v36
    v_cvt_pk_bf16_f32 v40, v38, v39
    v_sub_f32 v38, v18, v32
    v_sub_f32 v39, v19, v32
    v_cvt_pk_bf16_f32 v38, v38, v39
    v_and_b32 v39, 0xffff0000, v38
    v_lshlrev_b32 v38, 16, v38
    v_mul_f32 v38, v38, v36
    v_mul_f32 v39, v39, v36
    v_cvt_pk_bf16_f32 v41, v38, v39
    v_sub_f32 v38, v20, v32
    v_sub_f32 v39, v21, v32
    v_cvt_pk_bf16_f32 v38, v38, v39
    v_and_b32 v39, 0xffff0000, v38
    v_lshlrev_b32 v38, 16, v38
    v_mul_f32 v38, v38, v36
    v_mul_f32 v39, v39, v36
    v_cvt_pk_bf16_f32 v42, v38, v39
    v_sub_f32 v38, v22, v32
    v_sub_f32 v39, v23, v32
    v_cvt_pk_bf16_f32 v38, v38, v39
    v_and_b32 v39, 0xffff0000, v38
    v_lshlrev_b32 v38, 16, v38
    v_mul_f32 v38, v38, v36
    v_mul_f32 v39, v39, v36
    v_cvt_pk_bf16_f32 v43, v38, v39
    v_sub_f32 v38, v24, v33
    v_sub_f32 v39, v25, v33
    v_cvt_pk_bf16_f32 v38, v38, v39
    v_and_b32 v39, 0xffff0000, v38
    v_lshlrev_b32 v38, 16, v38
    v_mul_f32 v38, v38, v37
    v_mul_f32 v39, v39, v37
    v_cvt_pk_bf16_f32 v44, v38, v39
    v_sub_f32 v38, v26, v33
    v_sub_f32 v39, v27, v33
    v_cvt_pk_bf16_f32 v38, v38, v39
    v_and_b32 v39, 0xffff0000, v38
    v_lshlrev_b32 v38, 16, v38
    v_mul_f32 v38, v38, v37
    v_mul_f32 v39, v39, v37
    v_cvt_pk_bf16_f32 v45, v38, v39
    v_sub_f32 v38, v28, v33
    v_sub_f32 v39, v29, v33
    v_cvt_pk_bf16_f32 v38, v38, v39
    v_and_b32 v39, 0xffff0000, v38
    v_lshlrev_b32 v38, 16, v38
    v_mul_f32 v38, v38, v37
    v_mul_f32 v39, v39, v37
    v_cvt_pk_bf16_f32 v46, v38, v39
    v_sub_f32 v38, v30, v33
    v_sub_f32 v39, v31, v33
    v_cvt_pk_bf16_f32 v38, v38, v39
    v_and_b32 v39, 0xffff0000, v38
    v_lshlrev_b32 v38, 16, v38
    v_mul_f32 v38, v38, v37
    v_mul_f32 v39, v39, v37
    v_cvt_pk_bf16_f32 v47, v38, v39
    ds_write_b64 v6, v[40:41]
    ds_write_b64 v6, v[42:43] offset:128
    ds_write_b64 v6, v[44:45] offset:16
    ds_write_b64 v6, v[46:47] offset:144
    s_waitcnt lgkmcnt(0)
    s_add_u32 s34, s34, 1
    s_xor_b32 s75, s34, s74
    v_mov_b32 v125, s34
    v_mov_b32 v127, s75
    ds_write_b32 v3, v125 offset:192
    s_waitcnt lgkmcnt(0)
    s_mov_b64 exec, 1
    ds_add_u32 v3, v5 offset:4
    s_mov_b64 exec, -1
    s_cmp_lt_u32 s32, 2
    s_cbranch_scc0 L_noq
    s_mov_b32 s61, 0
WL_22:
    ds_read_b32 v4, v3 offset:4
    s_waitcnt lgkmcnt(0)
    v_readfirstlane_b32 s60, v4
    s_add_u32 s61, s61, 1
    s_cmp_ge_i32 s60, 4
    s_cbranch_scc1 WD_23
    s_cmp_lt_u32 s61, 1048576
    s_cbranch_scc1 WL_22
WD_23:
    ds_read_b128 v[64:67], v52 offset:0
    ds_read_b128 v[68:71], v52 offset:512
    ds_read_b128 v[72:75], v52 offset:1024
    ds_read_b128 v[76:79], v52 offset:1536
    s_mov_b32 s61, 0
WL_24:
    ds_read_b32 v4, v3 offset:0
    s_waitcnt lgkmcnt(0)
    v_readfirstlane_b32 s60, v4
    s_add_u32 s61, s61, 1
    s_cmp_ge_i32 s60, 16
    s_cbranch_scc1 WD_25
    s_cmp_lt_u32 s61, 1048576
    s_cbranch_scc1 WL_24
WD_25:
    ds_read_b64_tr_b16 v[80:81], v53 offset:0
    ds_read_b64_tr_b16 v[82:83], v53 offset:2048
    ds_read_b64_tr_b16 v[84:85], v53 offset:4096
    ds_read_b64_tr_b16 v[86:87], v53 offset:6144
    ds_read_b64_tr_b16 v[88:89], v53 offset:8192
    ds_read_b64_tr_b16 v[90:91], v53 offset:10240
    ds_read_b64_tr_b16 v[92:93], v53 offset:12288
    ds_read_b64_tr_b16 v[94:95], v53 offset:14336
    ds_read_b64_tr_b16 v[16:17], v115 offset:0
    ds_read_b64_tr_b16 v[18:19], v115 offset:2048
    ds_read_b64_tr_b16 v[20:21], v115 offset:4096
    ds_read_b64_tr_b16 v[22:23], v115 offset:6144
    ds_read_b64_tr_b16 v[24:25], v115 offset:8192
    ds_read_b64_tr_b16 v[26:27], v115 offset:10240
    s_waitcnt lgkmcnt(12)
    v_mfma_f32_16x16x32_bf16 v[96:99], v[80:83], v[64:67], 0
    ds_read_b64_tr_b16 v[28:29], v115 offset:12288
    ds_read_b64_tr_b16 v[30:31], v115 offset:14336
    s_waitcnt lgkmcnt(10)
    v_mfma_f32_16x16x32_bf16 v[96:99], v[84:87], v[68:71], v[96:99]
    s_waitcnt lgkmcnt(8)
    v_mfma_f32_16x16x32_bf16 v[96:99], v[88:91], v[72:75], v[96:99]
    s_waitcnt lgkmcnt(6)
    v_mfma_f32_16x16x32_bf16 v[96:99], v[92:95], v[76:79], v[96:99]
    s_waitcnt lgkmcnt(6)
    v_mfma_f32_16x16x32_bf16 v[104:107], v[16:19], v[64:67], 0
    s_waitcnt lgkmcnt(4)
    v_mfma_f32_16x16x32_bf16 v[104:107], v[20:23], v[68:71], v[104:107]
    s_waitcnt lgkmcnt(2)
    v_mfma_f32_16x16x32_bf16 v[104:107], v[24:27], v[72:75], v[104:107]
    s_waitcnt lgkmcnt(0)
    v_mfma_f32_16x16x32_bf16 v[104:107], v[28:31], v[76:79], v[104:107]
    s_mul_i32 s48, s32, 768
    s_add_u32 s48, s48, 162048
    v_lshlrev_b32 v16, 3, v0
    v_add_u32 v16, s48, v16
    v_lshlrev_b32 v17, 2, v0
    v_add_u32 v17, s48, v17
    s_nop 2
    v_cvt_pk_bf16_f32 v96, v96, v97
    v_cvt_pk_bf16_f32 v98, v98, v99
    v_cvt_pk_bf16_f32 v104, v104, v105
    v_cvt_pk_bf16_f32 v106, v106, v107
    v_cndmask_b32 v124, v104, v96, s[58:59]
    v_cndmask_b32 v126, v106, v98, s[58:59]
    global_store_dwordx4 v54, v[124:127], s[26:27]
    v_mov_b32 v18, v124
    v_mov_b32 v19, v126
    ds_write_b64 v16, v[18:19]
    ds_write_b32 v17, v54 offset:512
    s_waitcnt lgkmcnt(0)
    s_mov_b64 exec, 1
    ds_add_u32 v3, v5 offset:8
    s_mov_b64 exec, -1
L_noq:
    v_xor_b32 v58, v2, v1
    v_lshlrev_b32 v58, 4, v58
    v_lshl_add_u32 v58, v1, 8, v58
    s_lshl_b32 s48, s32, 14
    s_add_u32 s48, s48, 0
    v_add_u32 v58, s48, v58
    v_xor_b32 v59, 64, v58
    v_xor_b32 v60, 0x80, v58
    v_xor_b32 v61, 0xc0, v58
    v_lshlrev_b32 v56, 4, v0
    v_add_u32 v56, 155648, v56
    s_lshl_b32 s48, s32, 10
    v_add_u32 v57, s48, v56
    s_mov_b32 s61, 0
WL_26:
    ds_read_b32 v4, v3 offset:0
    s_waitcnt lgkmcnt(0)
    v_readfirstlane_b32 s60, v4
    s_add_u32 s61, s61, 1
    s_cmp_ge_i32 s60, 48
    s_cbranch_scc1 WD_27
    s_sleep 1
    s_cmp_lt_u32 s61, 1048576
    s_cbranch_scc1 WL_26
WD_27:
    s_mov_b32 s61, 0
    s_mov_b64 s[64:65], -1
PL_28:
    s_mov_b64 exec, s[64:65]
    s_cmp_ge_u32 s61, 16
    s_cbranch_scc1 PS_31
    global_load_dwordx4 v[64:67], v55, s[26:27] nt
    global_load_dwordx4 v[68:71], v55, s[26:27] offset:16 nt
    s_mov_b64 exec, -1
    s_branch PC_30
PS_31:
    global_load_dwordx4 v[64:67], v55, s[26:27] sc1
    global_load_dwordx4 v[68:71], v55, s[26:27] offset:16 sc1
    s_mov_b64 exec, -1
PC_30:
    s_waitcnt vmcnt(0)
    v_xor_b32 v72, s34, v65
    v_xor_b32 v73, s34, v69
    v_xor_b32 v74, s75, v67
    v_xor_b32 v75, s75, v71
    v_or_b32 v74, v74, v75
    v_and_b32 v75, 0x0fffffff, v74
    v_or3_b32 v72, v72, v73, v75
    v_cmp_ne_u32 s[64:65], 0, v72
    s_cmp_eq_u64 s[64:65], 0
    s_cbranch_scc1 PD_29
    s_add_u32 s61, s61, 1
    s_sleep 8
    s_cmp_lt_u32 s61, 131072
    s_cbranch_scc1 PL_28
PD_29:
    v_cmp_ne_u32 s[64:65], 0, v74
    s_cmp_eq_u64 s[64:65], 0
    s_cbranch_scc1 L_samex
    s_mov_b64 exec, 1
    ds_add_u32 v3, v5 offset:36
    s_mov_b64 exec, -1
L_samex:
    v_mov_b32 v65, v66
    v_mov_b32 v66, v68
    v_mov_b32 v67, v70
    ds_write_b128 v57, v[64:67]
    s_waitcnt lgkmcnt(0)
    s_mov_b64 exec, 1
    ds_add_u32 v3, v5 offset:12
    s_mov_b64 exec, -1
    s_mov_b32 s61, 0
WL_32:
    ds_read_b32 v4, v3 offset:12
    s_waitcnt lgkmcnt(0)
    v_readfirstlane_b32 s60, v4
    s_add_u32 s61, s61, 1
    s_cmp_ge_i32 s60, 4
    s_cbranch_scc1 WD_33
    s_cmp_lt_u32 s61, 1048576
    s_cbranch_scc1 WL_32
WD_33:
    ds_read_b32 v4, v3 offset:36
    s_waitcnt lgkmcnt(0)
    v_readfirstlane_b32 s76, v4
    ds_read_b128 v[64:67], v56 offset:0
    ds_read_b128 v[68:71], v56 offset:1024
    ds_read_b128 v[72:75], v56 offset:2048
    ds_read_b128 v[76:79], v56 offset:3072
    s_lshr_b32 s48, s39, 4
    s_xor_b32 s48, s48, s32
    s_lshl_b32 s48, s48, 4
    s_add_u32 s48, s48, s35
    s_add_u32 s48, s48, 16
    s_mov_b32 s61, 0
WL_34:
    ds_read_b32 v4, v3 offset:0
    s_waitcnt lgkmcnt(0)
    v_readfirstlane_b32 s60, v4
    s_add_u32 s61, s61, 1
    s_cmp_ge_i32 s60, s48
    s_cbranch_scc1 WD_35
    s_sleep 1
    s_cmp_lt_u32 s61, 1048576
    s_cbranch_scc1 WL_34
WD_35:
    ds_read_b128 v[16:19], v58 offset:0
    ds_read_b128 v[20:23], v59 offset:0
    ds_read_b128 v[24:27], v60 offset:0
    ds_read_b128 v[28:31], v61 offset:0
    ds_read_b128 v[32:35], v58 offset:4096
    ds_read_b128 v[36:39], v59 offset:4096
    ds_read_b128 v[40:43], v60 offset:4096
    ds_read_b128 v[44:47], v61 offset:4096
    s_waitcnt lgkmcnt(7)
    v_mfma_f32_16x16x32_bf16 v[96:99], v[16:19], v[64:67], 0
    s_waitcnt lgkmcnt(6)
    v_mfma_f32_16x16x32_bf16 v[96:99], v[20:23], v[68:71], v[96:99]
    s_waitcnt lgkmcnt(5)
    v_mfma_f32_16x16x32_bf16 v[96:99], v[24:27], v[72:75], v[96:99]
    s_waitcnt lgkmcnt(4)
    v_mfma_f32_16x16x32_bf16 v[96:99], v[28:31], v[76:79], v[96:99]
    ds_read_b128 v[16:19], v58 offset:8192
    ds_read_b128 v[20:23], v59 offset:8192
    ds_read_b128 v[24:27], v60 offset:8192
    ds_read_b128 v[28:31], v61 offset:8192
    s_waitcnt lgkmcnt(7)
    v_mfma_f32_16x16x32_bf16 v[100:103], v[32:35], v[64:67], 0
    s_waitcnt lgkmcnt(6)
    v_mfma_f32_16x16x32_bf16 v[100:103], v[36:39], v[68:71], v[100:103]
    s_waitcnt lgkmcnt(5)
    v_mfma_f32_16x16x32_bf16 v[100:103], v[40:43], v[72:75], v[100:103]
    s_waitcnt lgkmcnt(4)
    v_mfma_f32_16x16x32_bf16 v[100:103], v[44:47], v[76:79], v[100:103]
    ds_read_b128 v[32:35], v58 offset:12288
    ds_read_b128 v[36:39], v59 offset:12288
    ds_read_b128 v[40:43], v60 offset:12288
    ds_read_b128 v[44:47], v61 offset:12288
    s_waitcnt lgkmcnt(7)
    v_mfma_f32_16x16x32_bf16 v[104:107], v[16:19], v[64:67], 0
    s_waitcnt lgkmcnt(6)
    v_mfma_f32_16x16x32_bf16 v[104:107], v[20:23], v[68:71], v[104:107]
    s_waitcnt lgkmcnt(5)
    v_mfma_f32_16x16x32_bf16 v[104:107], v[24:27], v[72:75], v[104:107]
    s_waitcnt lgkmcnt(4)
    v_mfma_f32_16x16x32_bf16 v[104:107], v[28:31], v[76:79], v[104:107]
    s_waitcnt lgkmcnt(3)
    v_mfma_f32_16x16x32_bf16 v[108:111], v[32:35], v[64:67], 0
    s_waitcnt lgkmcnt(2)
    v_mfma_f32_16x16x32_bf16 v[108:111], v[36:39], v[68:71], v[108:111]
    s_waitcnt lgkmcnt(1)
    v_mfma_f32_16x16x32_bf16 v[108:111], v[40:43], v[72:75], v[108:111]
    s_waitcnt lgkmcnt(0)
    v_mfma_f32_16x16x32_bf16 v[108:111], v[44:47], v[76:79], v[108:111]
    s_nop 7
    v_add_f32_dpp v96, v96, v96 row_ror:4 row_mask:0xf bank_mask:0xf
    v_add_f32_dpp v97, v97, v97 row_ror:4 row_mask:0xf bank_mask:0xf
    v_add_f32_dpp v98, v98, v98 row_ror:4 row_mask:0xf bank_mask:0xf
    v_add_f32_dpp v99, v99, v99 row_ror:4 row_mask:0xf bank_mask:0xf
    v_add_f32_dpp v100, v100, v100 row_ror:4 row_mask:0xf bank_mask:0xf
    v_add_f32_dpp v101, v101, v101 row_ror:4 row_mask:0xf bank_mask:0xf
    v_add_f32_dpp v102, v102, v102 row_ror:4 row_mask:0xf bank_mask:0xf
    v_add_f32_dpp v103, v103, v103 row_ror:4 row_mask:0xf bank_mask:0xf
    v_add_f32_dpp v104, v104, v104 row_ror:4 row_mask:0xf bank_mask:0xf
    v_add_f32_dpp v105, v105, v105 row_ror:4 row_mask:0xf bank_mask:0xf
    v_add_f32_dpp v106, v106, v106 row_ror:4 row_mask:0xf bank_mask:0xf
    v_add_f32_dpp v107, v107, v107 row_ror:4 row_mask:0xf bank_mask:0xf
    v_add_f32_dpp v108, v108, v108 row_ror:4 row_mask:0xf bank_mask:0xf
    v_add_f32_dpp v109, v109, v109 row_ror:4 row_mask:0xf bank_mask:0xf
    v_add_f32_dpp v110, v110, v110 row_ror:4 row_mask:0xf bank_mask:0xf
    v_add_f32_dpp v111, v111, v111 row_ror:4 row_mask:0xf bank_mask:0xf
    v_add_f32_dpp v96, v96, v96 row_ror:8 row_mask:0xf bank_mask:0xf
    v_add_f32_dpp v97, v97, v97 row_ror:8 row_mask:0xf bank_mask:0xf
    v_add_f32_dpp v98, v98, v98 row_ror:8 row_mask:0xf bank_mask:0xf
    v_add_f32_dpp v99, v99, v99 row_ror:8 row_mask:0xf bank_mask:0xf
    v_add_f32_dpp v100, v100, v100 row_ror:8 row_mask:0xf bank_mask:0xf
    v_add_f32_dpp v101, v101, v101 row_ror:8 row_mask:0xf bank_mask:0xf
    v_add_f32_dpp v102, v102, v102 row_ror:8 row_mask:0xf bank_mask:0xf
    v_add_f32_dpp v103, v103, v103 row_ror:8 row_mask:0xf bank_mask:0xf
    v_add_f32_dpp v104, v104, v104 row_ror:8 row_mask:0xf bank_mask:0xf
    v_add_f32_dpp v105, v105, v105 row_ror:8 row_mask:0xf bank_mask:0xf
    v_add_f32_dpp v106, v106, v106 row_ror:8 row_mask:0xf bank_mask:0xf
    v_add_f32_dpp v107, v107, v107 row_ror:8 row_mask:0xf bank_mask:0xf
    v_add_f32_dpp v108, v108, v108 row_ror:8 row_mask:0xf bank_mask:0xf
    v_add_f32_dpp v109, v109, v109 row_ror:8 row_mask:0xf bank_mask:0xf
    v_add_f32_dpp v110, v110, v110 row_ror:8 row_mask:0xf bank_mask:0xf
    v_add_f32_dpp v111, v111, v111 row_ror:8 row_mask:0xf bank_mask:0xf
    v_mul_f32 v96, 0x3e0293ee, v96
    v_mul_f32 v97, 0x3e0293ee, v97
    v_mul_f32 v98, 0x3e0293ee, v98
    v_mul_f32 v99, 0x3e0293ee, v99
    v_mul_f32 v100, 0x3e0293ee, v100
    v_mul_f32 v101, 0x3e0293ee, v101
    v_mul_f32 v102, 0x3e0293ee, v102
    v_mul_f32 v103, 0x3e0293ee, v103
    v_mul_f32 v104, 0x3e0293ee, v104
    v_mul_f32 v105, 0x3e0293ee, v105
    v_mul_f32 v106, 0x3e0293ee, v106
    v_mul_f32 v107, 0x3e0293ee, v107
    v_mul_f32 v108, 0x3e0293ee, v108
    v_mul_f32 v109, 0x3e0293ee, v109
    v_mul_f32 v110, 0x3e0293ee, v110
    v_mul_f32 v111, 0x3e0293ee, v111
    v_max3_f32 v16, v96, v97, v98
    v_max3_f32 v16, v16, v99, v100
    v_max3_f32 v16, v16, v101, v102
    v_max3_f32 v16, v16, v103, v104
    v_max3_f32 v16, v16, v105, v106
    v_max3_f32 v16, v16, v107, v108
    v_max3_f32 v16, v16, v109, v110
    v_max_f32 v16, v16, v111
    v_mov_b32 v17, v16
    s_nop 1
    v_permlane16_swap_b32 v16, v17
    s_nop 0
    v_max_f32 v16, v16, v17
    v_mov_b32 v17, v16
    s_nop 1
    v_permlane32_swap_b32 v16, v17
    s_nop 0
    v_max_f32 v16, v16, v17
    v_lshlrev_b32 v18, 2, v114
    v_add_u32 v19, 161792, v18
    v_mov_b32 v57, v19
    s_lshl_b32 s48, s32, 4
    v_add_u32 v18, s48, v19
    ds_write_b32 v18, v16 offset:64
    s_waitcnt lgkmcnt(0)
    s_mov_b64 exec, 1
    ds_add_u32 v3, v5 offset:16
    s_mov_b64 exec, -1
    s_mov_b32 s61, 0
WL_36:
    ds_read_b32 v4, v3 offset:16
    s_waitcnt lgkmcnt(0)
    v_readfirstlane_b32 s60, v4
    s_add_u32 s61, s61, 1
    s_cmp_ge_i32 s60, 4
    s_cbranch_scc1 WD_37
    s_cmp_lt_u32 s61, 1048576
    s_cbranch_scc1 WL_36
WD_37:
    ds_read_b32 v20, v19 offset:64
    ds_read_b32 v21, v19 offset:80
    ds_read_b32 v22, v19 offset:96
    ds_read_b32 v23, v19 offset:112
    s_waitcnt lgkmcnt(0)
    v_max3_f32 v62, v20, v21, v22
    v_max_f32 v62, v62, v23
    v_sub_f32 v96, v96, v62
    v_sub_f32 v97, v97, v62
    v_sub_f32 v98, v98, v62
    v_sub_f32 v99, v99, v62
    v_sub_f32 v100, v100, v62
    v_sub_f32 v101, v101, v62
    v_sub_f32 v102, v102, v62
    v_sub_f32 v103, v103, v62
    v_sub_f32 v104, v104, v62
    v_sub_f32 v105, v105, v62
    v_sub_f32 v106, v106, v62
    v_sub_f32 v107, v107, v62
    v_sub_f32 v108, v108, v62
    v_sub_f32 v109, v109, v62
    v_sub_f32 v110, v110, v62
    v_sub_f32 v111, v111, v62
    v_exp_f32 v96, v96
    v_exp_f32 v97, v97
    v_exp_f32 v98, v98
    v_exp_f32 v99, v99
    v_exp_f32 v100, v100
    v_exp_f32 v101, v101
    v_exp_f32 v102, v102
    v_exp_f32 v103, v103
    v_exp_f32 v104, v104
    v_exp_f32 v105, v105
    v_exp_f32 v106, v106
    v_exp_f32 v107, v107
    v_exp_f32 v108, v108
    v_exp_f32 v109, v109
    v_exp_f32 v110, v110
    v_exp_f32 v111, v111
    s_nop 0
    v_add_f32 v16, v96, v97
    v_add_f32 v16, v16, v98
    v_add_f32 v16, v16, v99
    v_add_f32 v16, v16, v100
    v_add_f32 v16, v16, v101
    v_add_f32 v16, v16, v102
    v_add_f32 v16, v16, v103
    v_add_f32 v16, v16, v104
    v_add_f32 v16, v16, v105
    v_add_f32 v16, v16, v106
    v_add_f32 v16, v16, v107
    v_add_f32 v16, v16, v108
    v_add_f32 v16, v16, v109
    v_add_f32 v16, v16, v110
    v_add_f32 v16, v16, v111
    v_mov_b32 v17, v16
    s_nop 1
    v_permlane16_swap_b32 v16, v17
    s_nop 0
    v_add_f32 v16, v16, v17
    v_mov_b32 v17, v16
    s_nop 1
    v_permlane32_swap_b32 v16, v17
    s_nop 0
    v_add_f32 v16, v16, v17
    ds_write_b32 v18, v16 offset:128
    v_cvt_pk_bf16_f32 v24, v96, v97
    v_cvt_pk_bf16_f32 v25, v98, v99
    v_cvt_pk_bf16_f32 v26, v100, v101
    v_cvt_pk_bf16_f32 v27, v102, v103
    v_cvt_pk_bf16_f32 v28, v104, v105
    v_cvt_pk_bf16_f32 v29, v106, v107
    v_cvt_pk_bf16_f32 v30, v108, v109
    v_cvt_pk_bf16_f32 v31, v110, v111
    v_lshl_add_u32 v63, v2, 2, v114
    v_lshlrev_b32 v63, 4, v63
    v_add_u32 v63, 159744, v63
    s_lshl_b32 s48, s32, 9
    v_add_u32 v21, s48, v63
    ds_write_b128 v21, v[24:27]
    ds_write_b128 v21, v[28:31] offset:256
    s_waitcnt lgkmcnt(0)
    s_mov_b64 exec, 1
    ds_add_u32 v3, v5 offset:20
    s_mov_b64 exec, -1
    s_lshr_b32 s52, s39, 3
    s_lshl_b32 s48, s32, 6
    s_lshl_b32 s50, s52, 13
    s_or_b32 s48, s48, s50
    s_or_b32 s48, s48, 65536
    v_xor_b32 v58, s48, v51
    s_lshl_b32 s48, s52, 8
    v_xor_b32 v63, s48, v63
    s_lshl_b32 s48, s28, 7
    s_lshl_b32 s50, s31, 3
    s_add_u32 s48, s48, s50
    s_add_u32 s48, s48, s30
    s_lshl_b32 s48, s48, 9
    s_lshl_b32 s50, s32, 7
    s_add_u32 s48, s48, s50
    s_add_u32 s48, s48, 655360
    v_lshlrev_b32 v60, 14, v114
    v_bfe_u32 v61, v0, 2, 1
    v_lshl_add_u32 v60, v61, 6, v60
    v_lshl_add_u32 v60, v2, 4, v60
    v_add_u32 v60, s48, v60
    s_lshl_b32 s48, s28, 2
    s_add_u32 s48, s48, s49
    s_lshl_b32 s48, s48, 14
    s_add_u32 s48, s48, s50
    s_add_u32 s48, s48, 655360
    v_lshlrev_b32 v61, 9, v1
    v_lshl_add_u32 v61, v2, 4, v61
    v_add_u32 v61, s48, v61
    v_add_u32 v56, 0x2000, v61
    v_lshl_add_u32 v116, v2, 3, v112
    v_lshlrev_b32 v116, 4, v116
    v_add_u32 v116, 16384, v116
    s_lshl_b32 s48, s32, 11
    v_add_u32 v117, s48, v116
    s_lshl_b32 s48, s32, 9
    v_add_u32 v118, s48, v116
    s_and_b32 s48, s29, 7
    s_lshl_b32 s48, s48, 2
    s_add_u32 s48, s48, s32
    s_lshl_b32 s48, s48, 5
    s_lshl_b32 s50, s28, 2
    s_add_u32 s48, s48, s50
    s_add_u32 s48, s48, s49
    s_lshl_b32 s48, s48, 7
    s_add_u32 s48, s48, 2097152
    v_lshlrev_b32 v55, 17, v112
    v_lshl_add_u32 v55, v2, 5, v55
    v_lshl_add_u32 v55, v113, 4, v55
    v_add_u32 v55, s48, v55
    s_lshl_b32 s48, s32, 12
    s_add_u32 s48, s48, 0
    v_add_u32 v53, s48, v50
    s_mov_b32 s56, 0x0f0f0f0f
    s_mov_b32 s57, 0x0f0f0f0f
    s_mov_b32 s61, 0
WL_38:
    ds_read_b32 v4, v3 offset:20
    s_waitcnt lgkmcnt(0)
    v_readfirstlane_b32 s60, v4
    s_add_u32 s61, s61, 1
    s_cmp_ge_i32 s60, 4
    s_cbranch_scc1 WD_39
    s_cmp_lt_u32 s61, 1048576
    s_cbranch_scc1 WL_38
WD_39:
    ds_read_b128 v[64:67], v63
    v_xor_b32 v52, 256, v63
    ds_read_b128 v[68:71], v52
    v_xor_b32 v52, 512, v63
    ds_read_b128 v[72:75], v52
    v_xor_b32 v52, 768, v63
    ds_read_b128 v[76:79], v52
    v_xor_b32 v52, 1024, v63
    ds_read_b128 v[80:83], v52
    v_xor_b32 v52, 1280, v63
    ds_read_b128 v[84:87], v52
    v_xor_b32 v52, 1536, v63
    ds_read_b128 v[88:91], v52
    v_xor_b32 v52, 1792, v63
    ds_read_b128 v[92:95], v52
    v_xor_b32 v59, 32, v58
    s_add_u32 s48, s36, 8
    s_mov_b32 s61, 0
WL_40:
    ds_read_b32 v4, v3 offset:0
    s_waitcnt lgkmcnt(0)
    v_readfirstlane_b32 s60, v4
    s_add_u32 s61, s61, 1
    s_cmp_ge_i32 s60, s48
    s_cbranch_scc1 WD_41
    s_sleep 1
    s_cmp_lt_u32 s61, 1048576
    s_cbranch_scc1 WL_40
WD_41:
    ds_read_b64_tr_b16 v[16:17], v58
    ds_read_b64_tr_b16 v[18:19], v58 offset:4096
    ds_read_b64_tr_b16 v[20:21], v59
    ds_read_b64_tr_b16 v[22:23], v59 offset:4096
    s_waitcnt lgkmcnt(2)
    v_mfma_f32_16x16x32_bf16 v[96:99], v[16:19], v[64:67], 0
    s_waitcnt lgkmcnt(0)
    v_mfma_f32_16x16x32_bf16 v[100:103], v[20:23], v[64:67], 0
    v_xor_b32 v52, 8192, v58
    v_xor_b32 v59, 32, v52
    s_add_u32 s48, s36, 16
    s_mov_b32 s61, 0
WL_42:
    ds_read_b32 v4, v3 offset:0
    s_waitcnt lgkmcnt(0)
    v_readfirstlane_b32 s60, v4
    s_add_u32 s61, s61, 1
    s_cmp_ge_i32 s60, s48
    s_cbranch_scc1 WD_43
    s_sleep 1
    s_cmp_lt_u32 s61, 1048576
    s_cbranch_scc1 WL_42
WD_43:
    ds_read_b64_tr_b16 v[24:25], v52
    ds_read_b64_tr_b16 v[26:27], v52 offset:4096
    ds_read_b64_tr_b16 v[28:29], v59
    ds_read_b64_tr_b16 v[30:31], v59 offset:4096
    s_waitcnt lgkmcnt(2)
    v_mfma_f32_16x16x32_bf16 v[96:99], v[24:27], v[68:71], v[96:99]
    s_waitcnt lgkmcnt(0)
    v_mfma_f32_16x16x32_bf16 v[100:103], v[28:31], v[68:71], v[100:103]
    v_xor_b32 v52, 16384, v58
    v_xor_b32 v59, 32, v52
    s_add_u32 s48, s36, 24
    s_mov_b32 s61, 0
WL_44:
    ds_read_b32 v4, v3 offset:0
    s_waitcnt lgkmcnt(0)
    v_readfirstlane_b32 s60, v4
    s_add_u32 s61, s61, 1
    s_cmp_ge_i32 s60, s48
    s_cbranch_scc1 WD_45
    s_sleep 1
    s_cmp_lt_u32 s61, 1048576
    s_cbranch_scc1 WL_44
WD_45:
    ds_read_b64_tr_b16 v[16:17], v52
    ds_read_b64_tr_b16 v[18:19], v52 offset:4096
    ds_read_b64_tr_b16 v[20:21], v59
    ds_read_b64_tr_b16 v[22:23], v59 offset:4096
    s_waitcnt lgkmcnt(2)
    v_mfma_f32_16x16x32_bf16 v[96:99], v[16:19], v[72:75], v[96:99]
    s_waitcnt lgkmcnt(0)
    v_mfma_f32_16x16x32_bf16 v[100:103], v[20:23], v[72:75], v[100:103]
    v_xor_b32 v52, 24576, v58
    v_xor_b32 v59, 32, v52
    s_add_u32 s48, s36, 32
    s_mov_b32 s61, 0
WL_46:
    ds_read_b32 v4, v3 offset:0
    s_waitcnt lgkmcnt(0)
    v_readfirstlane_b32 s60, v4
    s_add_u32 s61, s61, 1
    s_cmp_ge_i32 s60, s48
    s_cbranch_scc1 WD_47
    s_sleep 1
    s_cmp_lt_u32 s61, 1048576
    s_cbranch_scc1 WL_46
WD_47:
    ds_read_b64_tr_b16 v[24:25], v52
    ds_read_b64_tr_b16 v[26:27], v52 offset:4096
    ds_read_b64_tr_b16 v[28:29], v59
    ds_read_b64_tr_b16 v[30:31], v59 offset:4096
    s_waitcnt lgkmcnt(2)
    v_mfma_f32_16x16x32_bf16 v[96:99], v[24:27], v[76:79], v[96:99]
    s_waitcnt lgkmcnt(0)
    v_mfma_f32_16x16x32_bf16 v[100:103], v[28:31], v[76:79], v[100:103]
    v_xor_b32 v52, 32768, v58
    v_xor_b32 v59, 32, v52
    s_add_u32 s48, s36, 40
    s_mov_b32 s61, 0
WL_48:
    ds_read_b32 v4, v3 offset:0
    s_waitcnt lgkmcnt(0)
    v_readfirstlane_b32 s60, v4
    s_add_u32 s61, s61, 1
    s_cmp_ge_i32 s60, s48
    s_cbranch_scc1 WD_49
    s_sleep 1
    s_cmp_lt_u32 s61, 1048576
    s_cbranch_scc1 WL_48
WD_49:
    ds_read_b64_tr_b16 v[16:17], v52
    ds_read_b64_tr_b16 v[18:19], v52 offset:4096
    ds_read_b64_tr_b16 v[20:21], v59
    ds_read_b64_tr_b16 v[22:23], v59 offset:4096
    s_waitcnt lgkmcnt(2)
    v_mfma_f32_16x16x32_bf16 v[96:99], v[16:19], v[80:83], v[96:99]
    s_waitcnt lgkmcnt(0)
    v_mfma_f32_16x16x32_bf16 v[100:103], v[20:23], v[80:83], v[100:103]
    v_xor_b32 v52, 40960, v58
    v_xor_b32 v59, 32, v52
    s_add_u32 s48, s36, 48
    s_mov_b32 s61, 0
WL_50:
    ds_read_b32 v4, v3 offset:0
    s_waitcnt lgkmcnt(0)
    v_readfirstlane_b32 s60, v4
    s_add_u32 s61, s61, 1
    s_cmp_ge_i32 s60, s48
    s_cbranch_scc1 WD_51
    s_sleep 1
    s_cmp_lt_u32 s61, 1048576
    s_cbranch_scc1 WL_50
WD_51:
    ds_read_b64_tr_b16 v[24:25], v52
    ds_read_b64_tr_b16 v[26:27], v52 offset:4096
    ds_read_b64_tr_b16 v[28:29], v59
    ds_read_b64_tr_b16 v[30:31], v59 offset:4096
    s_waitcnt lgkmcnt(2)
    v_mfma_f32_16x16x32_bf16 v[96:99], v[24:27], v[84:87], v[96:99]
    s_waitcnt lgkmcnt(0)
    v_mfma_f32_16x16x32_bf16 v[100:103], v[28:31], v[84:87], v[100:103]
    v_xor_b32 v52, 49152, v58
    v_xor_b32 v59, 32, v52
    s_add_u32 s48, s36, 56
    s_mov_b32 s61, 0
WL_52:
    ds_read_b32 v4, v3 offset:0
    s_waitcnt lgkmcnt(0)
    v_readfirstlane_b32 s60, v4
    s_add_u32 s61, s61, 1
    s_cmp_ge_i32 s60, s48
    s_cbranch_scc1 WD_53
    s_cmp_lt_u32 s61, 1048576
    s_cbranch_scc1 WL_52
WD_53:
    ds_read_b64_tr_b16 v[16:17], v52
    ds_read_b64_tr_b16 v[18:19], v52 offset:4096
    ds_read_b64_tr_b16 v[20:21], v59
    ds_read_b64_tr_b16 v[22:23], v59 offset:4096
    s_waitcnt lgkmcnt(2)
    v_mfma_f32_16x16x32_bf16 v[96:99], v[16:19], v[88:91], v[96:99]
    s_waitcnt lgkmcnt(0)
    v_mfma_f32_16x16x32_bf16 v[100:103], v[20:23], v[88:91], v[100:103]
    s_mov_b32 s61, 0
WL_54:
    ds_read_b32 v4, v3 offset:32
    s_waitcnt lgkmcnt(0)
    v_readfirstlane_b32 s60, v4
    s_add_u32 s61, s61, 1
    s_cmp_ge_i32 s60, 1
    s_cbranch_scc1 WD_55
    s_sleep 1
    s_cmp_lt_u32 s61, 1048576
    s_cbranch_scc1 WL_54
WD_55:
    ds_read_b32 v46, v57 offset:208
    v_mov_b32 v41, s34
    v_mov_b32 v43, s34
    v_xor_b32 v52, 57344, v58
    v_xor_b32 v59, 32, v52
    s_add_u32 s48, s36, 64
    s_mov_b32 s61, 0
WL_56:
    ds_read_b32 v4, v3 offset:0
    s_waitcnt lgkmcnt(0)
    v_readfirstlane_b32 s60, v4
    s_add_u32 s61, s61, 1
    s_cmp_ge_i32 s60, s48
    s_cbranch_scc1 WD_57
    s_cmp_lt_u32 s61, 1048576
    s_cbranch_scc1 WL_56
WD_57:
    ds_read_b64_tr_b16 v[24:25], v52
    ds_read_b64_tr_b16 v[26:27], v52 offset:4096
    ds_read_b64_tr_b16 v[28:29], v59
    ds_read_b64_tr_b16 v[30:31], v59 offset:4096
    s_waitcnt lgkmcnt(2)
    v_mfma_f32_16x16x32_bf16 v[96:99], v[24:27], v[92:95], v[96:99]
    s_waitcnt lgkmcnt(0)
    v_mfma_f32_16x16x32_bf16 v[100:103], v[28:31], v[92:95], v[100:103]
    s_nop 6
    v_mul_f32 v96, v96, v46
    v_mul_f32 v97, v97, v46
    v_mul_f32 v98, v98, v46
    v_mul_f32 v99, v99, v46
    v_mul_f32 v100, v100, v46
    v_mul_f32 v101, v101, v46
    v_mul_f32 v102, v102, v46
    v_mul_f32 v103, v103, v46
    v_cvt_pk_bf16_f32 v96, v96, v97
    v_cvt_pk_bf16_f32 v98, v98, v99
    v_cvt_pk_bf16_f32 v100, v100, v101
    v_cvt_pk_bf16_f32 v102, v102, v103
    v_cndmask_b32 v40, v100, v96, s[56:57]
    v_cndmask_b32 v42, v102, v98, s[56:57]
    s_mov_b64 exec, s[58:59]
    s_cmp_eq_u32 s76, 0
    s_cbranch_scc0 L_osc1
    global_store_dwordx4 v60, v[40:43], s[26:27]
    s_branch L_opub
L_osc1:
    global_store_dwordx4 v60, v[40:43], s[26:27] sc1
L_opub:
    s_mov_b64 exec, -1
    global_load_dwordx4 v[24:27], v61, s[26:27] nt
    global_load_dwordx4 v[28:31], v61, s[26:27] offset:64 nt
    global_load_dwordx4 v[32:35], v56, s[26:27] nt
    global_load_dwordx4 v[36:39], v56, s[26:27] offset:64 nt
    s_mov_b32 s61, 0
WL_58:
    ds_read_b32 v4, v3 offset:0
    s_waitcnt lgkmcnt(0)
    v_readfirstlane_b32 s60, v4
    s_add_u32 s61, s61, 1
    s_cmp_ge_i32 s60, s37
    s_cbranch_scc1 WD_59
    s_cmp_lt_u32 s61, 1048576
    s_cbranch_scc1 WL_58
WD_59:
    ds_read_b64_tr_b16 v[64:65], v53
    ds_read_b64_tr_b16 v[66:67], v53 offset:2048
    v_xor_b32 v52, 32, v53
    ds_read_b64_tr_b16 v[68:69], v52
    ds_read_b64_tr_b16 v[70:71], v52 offset:2048
    v_xor_b32 v52, 64, v53
    ds_read_b64_tr_b16 v[72:73], v52
    ds_read_b64_tr_b16 v[74:75], v52 offset:2048
    v_xor_b32 v52, 96, v53
    ds_read_b64_tr_b16 v[76:77], v52
    ds_read_b64_tr_b16 v[78:79], v52 offset:2048
    s_mov_b32 s61, 0
    s_branch PC_62
PL_60:
    s_mov_b64 exec, s[64:65]
    s_cmp_ge_u32 s61, 32
    s_cbranch_scc1 PS_63
    global_load_dwordx4 v[24:27], v61, s[26:27] nt
    global_load_dwordx4 v[28:31], v61, s[26:27] offset:64 nt
    global_load_dwordx4 v[32:35], v56, s[26:27] nt
    global_load_dwordx4 v[36:39], v56, s[26:27] offset:64 nt
    s_mov_b64 exec, -1
    s_branch PC_62
PS_63:
    global_load_dwordx4 v[24:27], v61, s[26:27] sc1
    global_load_dwordx4 v[28:31], v61, s[26:27] offset:64 sc1
    global_load_dwordx4 v[32:35], v56, s[26:27] sc1
    global_load_dwordx4 v[36:39], v56, s[26:27] offset:64 sc1
    s_mov_b64 exec, -1
PC_62:
    s_waitcnt vmcnt(0)
    v_xor_b32 v44, s34, v25
    v_xor_b32 v45, s34, v27
    v_xor_b32 v119, s34, v29
    v_or3_b32 v44, v44, v45, v119
    v_xor_b32 v45, s34, v31
    v_xor_b32 v119, s34, v33
    v_or3_b32 v44, v44, v45, v119
    v_xor_b32 v45, s34, v35
    v_xor_b32 v119, s34, v37
    v_or3_b32 v44, v44, v45, v119
    v_xor_b32 v45, s34, v39
    v_or_b32 v44, v44, v45
    v_cmp_ne_u32 s[64:65], 0, v44
    s_cmp_eq_u64 s[64:65], 0
    s_cbranch_scc1 PD_61
    s_add_u32 s61, s61, 1
    s_cmp_lt_u32 s61, 131072
    s_cbranch_scc1 PL_60
PD_61:
    v_mov_b32 v25, v26
    v_mov_b32 v26, v28
    v_mov_b32 v27, v30
    v_mov_b32 v33, v34
    v_mov_b32 v34, v36
    v_mov_b32 v35, v38
    s_waitcnt lgkmcnt(0)
    s_nop 0
    v_mfma_f32_16x16x32_bf16 v[96:99], v[64:67], v[24:27], 0
    v_mfma_f32_16x16x32_bf16 v[100:103], v[68:71], v[24:27], 0
    v_mfma_f32_16x16x32_bf16 v[104:107], v[72:75], v[24:27], 0
    v_mfma_f32_16x16x32_bf16 v[108:111], v[76:79], v[24:27], 0
    v_mfma_f32_16x16x32_bf16 v[96:99], v[64:67], v[32:35], v[96:99]
    v_mfma_f32_16x16x32_bf16 v[100:103], v[68:71], v[32:35], v[100:103]
    v_mfma_f32_16x16x32_bf16 v[104:107], v[72:75], v[32:35], v[104:107]
    v_mfma_f32_16x16x32_bf16 v[108:111], v[76:79], v[32:35], v[108:111]
    v_mov_b32 v17, s34
    v_mov_b32 v19, s34
    s_nop 3
    v_add_f32_dpp v96, v96, v96 row_ror:8 row_mask:0xf bank_mask:0xf
    v_add_f32_dpp v97, v97, v97 row_ror:8 row_mask:0xf bank_mask:0xf
    v_add_f32_dpp v98, v98, v98 row_ror:8 row_mask:0xf bank_mask:0xf
    v_add_f32_dpp v99, v99, v99 row_ror:8 row_mask:0xf bank_mask:0xf
    s_mov_b64 exec, s[58:59]
    ds_write_b128 v117, v[96:99] offset:0
    s_mov_b64 exec, -1
    v_add_f32_dpp v100, v100, v100 row_ror:8 row_mask:0xf bank_mask:0xf
    v_add_f32_dpp v101, v101, v101 row_ror:8 row_mask:0xf bank_mask:0xf
    v_add_f32_dpp v102, v102, v102 row_ror:8 row_mask:0xf bank_mask:0xf
    v_add_f32_dpp v103, v103, v103 row_ror:8 row_mask:0xf bank_mask:0xf
    s_mov_b64 exec, s[58:59]
    ds_write_b128 v117, v[100:103] offset:512
    s_mov_b64 exec, -1
    v_add_f32_dpp v104, v104, v104 row_ror:8 row_mask:0xf bank_mask:0xf
    v_add_f32_dpp v105, v105, v105 row_ror:8 row_mask:0xf bank_mask:0xf
    v_add_f32_dpp v106, v106, v106 row_ror:8 row_mask:0xf bank_mask:0xf
    v_add_f32_dpp v107, v107, v107 row_ror:8 row_mask:0xf bank_mask:0xf
    s_mov_b64 exec, s[58:59]
    ds_write_b128 v117, v[104:107] offset:1024
    s_mov_b64 exec, -1
    s_nop 2
    v_add_f32_dpp v108, v108, v108 row_ror:8 row_mask:0xf bank_mask:0xf
    v_add_f32_dpp v109, v109, v109 row_ror:8 row_mask:0xf bank_mask:0xf
    v_add_f32_dpp v110, v110, v110 row_ror:8 row_mask:0xf bank_mask:0xf
    v_add_f32_dpp v111, v111, v111 row_ror:8 row_mask:0xf bank_mask:0xf
    s_mov_b64 exec, s[58:59]
    ds_write_b128 v117, v[108:111] offset:1536
    s_mov_b64 exec, -1
    s_waitcnt lgkmcnt(0)
    s_mov_b64 exec, 1
    ds_add_u32 v3, v5 offset:28
    s_mov_b64 exec, -1
    s_mov_b32 s61, 0
WL_64:
    ds_read_b32 v4, v3 offset:28
    s_waitcnt lgkmcnt(0)
    v_readfirstlane_b32 s60, v4
    s_add_u32 s61, s61, 1
    s_cmp_ge_i32 s60, 4
    s_cbranch_scc1 WD_65
    s_cmp_lt_u32 s61, 1048576
    s_cbranch_scc1 WL_64
WD_65:
    ds_read_b128 v[64:67], v118 offset:0
    ds_read_b128 v[68:71], v118 offset:2048
    ds_read_b128 v[72:75], v118 offset:4096
    ds_read_b128 v[76:79], v118 offset:6144
    s_waitcnt lgkmcnt(2)
    v_add_f32 v64, v64, v68
    v_add_f32 v65, v65, v69
    v_add_f32 v66, v66, v70
    v_add_f32 v67, v67, v71
    s_waitcnt lgkmcnt(0)
    v_add_f32 v72, v72, v76
    v_add_f32 v73, v73, v77
    v_add_f32 v74, v74, v78
    v_add_f32 v75, v75, v79
    v_add_f32 v64, v64, v72
    v_add_f32 v65, v65, v73
    v_add_f32 v66, v66, v74
    v_add_f32 v67, v67, v75
    v_cndmask_b32 v16, v66, v64, s[58:59]
    v_cndmask_b32 v18, v67, v65, s[58:59]
    global_store_dwordx4 v55, v[16:19], s[26:27] sc1
    s_endpgm
L_swave:
    v_and_b32 v1, 15, v0
    v_lshrrev_b32 v2, 4, v0
    s_barrier
    s_mov_b32 s61, 0
WL_66:
    ds_read_b32 v4, v3 offset:4
    s_waitcnt lgkmcnt(0)
    v_readfirstlane_b32 s60, v4
    s_add_u32 s61, s61, 1
    s_cmp_ge_i32 s60, 4
    s_cbranch_scc1 WD_67
    s_sleep 4
    s_cmp_lt_u32 s61, 1048576
    s_cbranch_scc1 WL_66
WD_67:
    ds_read_b32 v4, v3 offset:192
    s_waitcnt lgkmcnt(0)
    v_readfirstlane_b32 s34, v4
    v_and_b32 v114, 3, v0
    v_lshlrev_b32 v56, 2, v114
    v_add_u32 v56, 161792, v56
    s_lshl_b32 s51, s28, 3
    s_add_u32 s51, s51, s30
    s_lshl_b32 s51, s51, 9
    s_add_u32 s51, s51, 589824
    v_lshlrev_b32 v57, 4, v114
    v_lshl_add_u32 v57, v2, 7, v57
    v_add_u32 v57, s51, v57
    s_lshl_b32 s48, s31, 7
    s_add_u32 s48, s48, s51
    v_lshlrev_b32 v58, 4, v0
    v_add_u32 v58, s48, v58
    s_mov_b32 s61, 0
WL_68:
    ds_read_b32 v4, v3 offset:20
    s_waitcnt lgkmcnt(0)
    v_readfirstlane_b32 s60, v4
    s_add_u32 s61, s61, 1
    s_cmp_ge_i32 s60, 4
    s_cbranch_scc1 WD_69
    s_sleep 2
    s_cmp_lt_u32 s61, 1048576
    s_cbranch_scc1 WL_68
WD_69:
    ds_read_b32 v20, v56 offset:64
    ds_read_b32 v28, v56 offset:128
    ds_read_b32 v21, v56 offset:80
    ds_read_b32 v29, v56 offset:144
    ds_read_b32 v22, v56 offset:96
    ds_read_b32 v30, v56 offset:160
    ds_read_b32 v23, v56 offset:112
    ds_read_b32 v31, v56 offset:176
    ds_read_b32 v32, v3 offset:36
    s_waitcnt lgkmcnt(0)
    v_max3_f32 v62, v20, v21, v22
    v_max_f32 v62, v62, v23
    v_add_f32 v28, v28, v29
    v_add_f32 v30, v30, v31
    v_add_f32 v26, v28, v30
    v_mov_b32 v24, v62
    v_mov_b32 v25, s34
    v_mov_b32 v27, s34
    v_readfirstlane_b32 s76, v32
    s_mov_b64 exec, 0xff
    s_cmp_eq_u32 s76, 0
    s_cbranch_scc0 L_ssc1
    global_store_dwordx4 v58, v[24:27], s[26:27]
    s_branch L_spub
L_ssc1:
    global_store_dwordx4 v58, v[24:27], s[26:27] sc1
L_spub:
    s_mov_b64 exec, -1
    s_sleep 8
    s_mov_b32 s61, 0
    s_mov_b64 s[64:65], -1
PL_70:
    s_mov_b64 exec, s[64:65]
    s_cmp_ge_u32 s61, 16
    s_cbranch_scc1 PS_73
    global_load_dwordx4 v[40:43], v57, s[26:27] nt
    s_mov_b64 exec, -1
    s_branch PC_72
PS_73:
    global_load_dwordx4 v[40:43], v57, s[26:27] sc1
    s_mov_b64 exec, -1
PC_72:
    s_waitcnt vmcnt(0)
    v_xor_b32 v44, s34, v41
    v_xor_b32 v45, s34, v43
    v_or_b32 v44, v44, v45
    v_cmp_ne_u32 s[64:65], 0, v44
    s_cmp_eq_u64 s[64:65], 0
    s_cbranch_scc1 PD_71
    s_add_u32 s61, s61, 1
    s_sleep 8
    s_cmp_lt_u32 s61, 131072
    s_cbranch_scc1 PL_70
PD_71:
    v_mov_b32 v44, v40
    v_mov_b32 v45, v44
    s_nop 1
    v_permlane16_swap_b32 v44, v45
    s_nop 0
    v_max_f32 v44, v44, v45
    v_mov_b32 v45, v44
    s_nop 1
    v_permlane32_swap_b32 v44, v45
    s_nop 0
    v_max_f32 v44, v44, v45
    v_sub_f32 v40, v40, v44
    v_exp_f32 v40, v40
    v_sub_f32 v46, v62, v44
    v_exp_f32 v46, v46
    v_mul_f32 v42, v42, v40
    v_mov_b32 v45, v42
    s_nop 1
    v_permlane16_swap_b32 v42, v45
    s_nop 0
    v_add_f32 v42, v42, v45
    v_mov_b32 v45, v42
    s_nop 1
    v_permlane32_swap_b32 v42, v45
    s_nop 0
    v_add_f32 v42, v42, v45
    v_rcp_f32 v42, v42
    s_nop 0
    v_mul_f32 v46, v46, v42
    ds_write_b32 v56, v46 offset:208
    s_waitcnt lgkmcnt(0)
    s_mov_b64 exec, 1
    ds_add_u32 v3, v5 offset:32
    s_mov_b64 exec, -1
    s_endpgm
L_fwave:
    v_and_b32 v1, 15, v0
    v_lshrrev_b32 v2, 4, v0
    v_lshlrev_b32 v10, 4, v0
    s_barrier
    v_lshrrev_b32 v48, 2, v0
    v_and_b32 v49, 3, v0
    v_lshlrev_b32 v49, 3, v49
    v_bfe_u32 v50, v0, 3, 2
    v_lshl_or_b32 v50, v50, 5, v49
    v_lshl_add_u32 v50, v48, 7, v50
    v_and_b32 v51, 7, v48
    v_lshl_or_b32 v51, v51, 5, v49
    v_lshl_add_u32 v51, v48, 8, v51
    v_and_b32 v112, 7, v0
    v_bfe_u32 v113, v0, 3, 1
    s_lshl_b32 s52, s28, 2
    s_add_u32 s52, s52, s31
    s_lshl_b32 s53, s30, 10
    s_lshl_b32 s48, s52, 5
    s_add_u32 s53, s53, s48
    v_lshlrev_b32 v6, 2, v112
    v_add_u32 v6, s53, v6
    s_waitcnt lgkmcnt(0)
    global_load_dword v7, v6, s[4:5]
    s_lshl_b32 s48, s30, 5
    s_add_u32 s48, s48, s52
    s_lshl_b32 s48, s48, 12
    v_add_u32 v10, s48, v10
    v_add_u32 v11, 3145728, v10
    v_add_u32 v10, 2097152, v10
    s_mov_b32 s61, 0
WL_74:
    ds_read_b32 v4, v3 offset:4
    s_waitcnt lgkmcnt(0)
    v_readfirstlane_b32 s60, v4
    s_add_u32 s61, s61, 1
    s_cmp_ge_i32 s60, 4
    s_cbranch_scc1 WD_75
    s_sleep 1
    s_cmp_lt_u32 s61, 1048576
    s_cbranch_scc1 WL_74
WD_75:
    ds_read_b32 v4, v3 offset:192
    s_waitcnt lgkmcnt(0)
    v_readfirstlane_b32 s34, v4
    s_cmp_eq_u32 s33, 3
    s_cbranch_scc1 L_final
    s_cmp_eq_u32 s33, 2
    s_cbranch_scc1 L_dunit
    s_lshl_b32 s51, s68, 1
    s_and_b32 s48, s69, 1
    s_add_u32 s51, s51, s48
    v_lshlrev_b32 v52, 4, v112
    v_lshl_add_u32 v52, v2, 7, v52
    s_and_b32 s48, s51, 1
    s_lshl_b32 s48, s48, 12
    s_add_u32 s48, s48, 147456
    v_add_u32 v52, s48, v52
    v_add_u32 v53, 98304, v50
    s_mul_i32 s48, s33, 56
    s_add_u32 s48, s48, s51
    s_lshl_b32 s48, s48, 11
    s_add_u32 s48, s48, 1179648
    v_lshlrev_b32 v54, 8, v112
    v_lshl_add_u32 v54, v113, 6, v54
    v_lshl_add_u32 v54, v2, 4, v54
    v_add_u32 v54, s48, v54
    ds_read_b128 v[64:67], v52 offset:0
    ds_read_b128 v[68:71], v52 offset:512
    ds_read_b128 v[72:75], v52 offset:1024
    ds_read_b128 v[76:79], v52 offset:1536
    ds_read_b128 v[80:83], v52 offset:2048
    ds_read_b128 v[84:87], v52 offset:2560
    ds_read_b128 v[88:91], v52 offset:3072
    ds_read_b128 v[92:95], v52 offset:3584
    s_mov_b32 s61, 0
WL_76:
    ds_read_b32 v4, v3 offset:0
    s_waitcnt lgkmcnt(0)
    v_readfirstlane_b32 s60, v4
    s_add_u32 s61, s61, 1
    s_cmp_ge_i32 s60, s38
    s_cbranch_scc1 WD_77
    s_sleep 1
    s_cmp_lt_u32 s61, 1048576
    s_cbranch_scc1 WL_76
WD_77:
    ds_read_b64_tr_b16 v[16:17], v53 offset:0
    ds_read_b64_tr_b16 v[18:19], v53 offset:2048
    ds_read_b64_tr_b16 v[20:21], v53 offset:4096
    ds_read_b64_tr_b16 v[22:23], v53 offset:6144
    ds_read_b64_tr_b16 v[24:25], v53 offset:8192
    ds_read_b64_tr_b16 v[26:27], v53 offset:10240
    ds_read_b64_tr_b16 v[28:29], v53 offset:12288
    ds_read_b64_tr_b16 v[30:31], v53 offset:14336
    s_waitcnt lgkmcnt(6)
    v_mfma_f32_16x16x32_bf16 v[96:99], v[16:19], v[64:67], 0
    s_waitcnt lgkmcnt(4)
    v_mfma_f32_16x16x32_bf16 v[96:99], v[20:23], v[68:71], v[96:99]
    s_waitcnt lgkmcnt(2)
    v_mfma_f32_16x16x32_bf16 v[96:99], v[24:27], v[72:75], v[96:99]
    s_waitcnt lgkmcnt(0)
    v_mfma_f32_16x16x32_bf16 v[96:99], v[28:31], v[76:79], v[96:99]
    ds_read_b64_tr_b16 v[32:33], v53 offset:16384
    ds_read_b64_tr_b16 v[34:35], v53 offset:18432
    ds_read_b64_tr_b16 v[36:37], v53 offset:20480
    ds_read_b64_tr_b16 v[38:39], v53 offset:22528
    ds_read_b64_tr_b16 v[40:41], v53 offset:24576
    ds_read_b64_tr_b16 v[42:43], v53 offset:26624
    ds_read_b64_tr_b16 v[44:45], v53 offset:28672
    ds_read_b64_tr_b16 v[46:47], v53 offset:30720
    s_waitcnt lgkmcnt(6)
    v_mfma_f32_16x16x32_bf16 v[96:99], v[32:35], v[80:83], v[96:99]
    s_waitcnt lgkmcnt(4)
    v_mfma_f32_16x16x32_bf16 v[96:99], v[36:39], v[84:87], v[96:99]
    s_waitcnt lgkmcnt(2)
    v_mfma_f32_16x16x32_bf16 v[96:99], v[40:43], v[88:91], v[96:99]
    s_waitcnt lgkmcnt(0)
    v_mfma_f32_16x16x32_bf16 v[96:99], v[44:47], v[92:95], v[96:99]
    v_xor_b32 v55, 32, v53
    ds_read_b64_tr_b16 v[16:17], v55 offset:0
    ds_read_b64_tr_b16 v[18:19], v55 offset:2048
    ds_read_b64_tr_b16 v[20:21], v55 offset:4096
    ds_read_b64_tr_b16 v[22:23], v55 offset:6144
    ds_read_b64_tr_b16 v[24:25], v55 offset:8192
    ds_read_b64_tr_b16 v[26:27], v55 offset:10240
    ds_read_b64_tr_b16 v[28:29], v55 offset:12288
    ds_read_b64_tr_b16 v[30:31], v55 offset:14336
    s_waitcnt lgkmcnt(6)
    v_mfma_f32_16x16x32_bf16 v[100:103], v[16:19], v[64:67], 0
    s_waitcnt lgkmcnt(4)
    v_mfma_f32_16x16x32_bf16 v[100:103], v[20:23], v[68:71], v[100:103]
    s_waitcnt lgkmcnt(2)
    v_mfma_f32_16x16x32_bf16 v[100:103], v[24:27], v[72:75], v[100:103]
    s_waitcnt lgkmcnt(0)
    v_mfma_f32_16x16x32_bf16 v[100:103], v[28:31], v[76:79], v[100:103]
    ds_read_b64_tr_b16 v[32:33], v55 offset:16384
    ds_read_b64_tr_b16 v[34:35], v55 offset:18432
    ds_read_b64_tr_b16 v[36:37], v55 offset:20480
    ds_read_b64_tr_b16 v[38:39], v55 offset:22528
    ds_read_b64_tr_b16 v[40:41], v55 offset:24576
    ds_read_b64_tr_b16 v[42:43], v55 offset:26624
    ds_read_b64_tr_b16 v[44:45], v55 offset:28672
    ds_read_b64_tr_b16 v[46:47], v55 offset:30720
    s_waitcnt lgkmcnt(6)
    v_mfma_f32_16x16x32_bf16 v[100:103], v[32:35], v[80:83], v[100:103]
    s_waitcnt lgkmcnt(4)
    v_mfma_f32_16x16x32_bf16 v[100:103], v[36:39], v[84:87], v[100:103]
    s_waitcnt lgkmcnt(2)
    v_mfma_f32_16x16x32_bf16 v[100:103], v[40:43], v[88:91], v[100:103]
    s_waitcnt lgkmcnt(0)
    v_mfma_f32_16x16x32_bf16 v[100:103], v[44:47], v[92:95], v[100:103]
    v_xor_b32 v55, 64, v53
    ds_read_b64_tr_b16 v[16:17], v55 offset:0
    ds_read_b64_tr_b16 v[18:19], v55 offset:2048
    ds_read_b64_tr_b16 v[20:21], v55 offset:4096
    ds_read_b64_tr_b16 v[22:23], v55 offset:6144
    ds_read_b64_tr_b16 v[24:25], v55 offset:8192
    ds_read_b64_tr_b16 v[26:27], v55 offset:10240
    ds_read_b64_tr_b16 v[28:29], v55 offset:12288
    ds_read_b64_tr_b16 v[30:31], v55 offset:14336
    s_waitcnt lgkmcnt(6)
    v_mfma_f32_16x16x32_bf16 v[104:107], v[16:19], v[64:67], 0
    s_waitcnt lgkmcnt(4)
    v_mfma_f32_16x16x32_bf16 v[104:107], v[20:23], v[68:71], v[104:107]
    s_waitcnt lgkmcnt(2)
    v_mfma_f32_16x16x32_bf16 v[104:107], v[24:27], v[72:75], v[104:107]
    s_waitcnt lgkmcnt(0)
    v_mfma_f32_16x16x32_bf16 v[104:107], v[28:31], v[76:79], v[104:107]
    ds_read_b64_tr_b16 v[32:33], v55 offset:16384
    ds_read_b64_tr_b16 v[34:35], v55 offset:18432
    ds_read_b64_tr_b16 v[36:37], v55 offset:20480
    ds_read_b64_tr_b16 v[38:39], v55 offset:22528
    ds_read_b64_tr_b16 v[40:41], v55 offset:24576
    ds_read_b64_tr_b16 v[42:43], v55 offset:26624
    ds_read_b64_tr_b16 v[44:45], v55 offset:28672
    ds_read_b64_tr_b16 v[46:47], v55 offset:30720
    s_waitcnt lgkmcnt(6)
    v_mfma_f32_16x16x32_bf16 v[104:107], v[32:35], v[80:83], v[104:107]
    s_waitcnt lgkmcnt(4)
    v_mfma_f32_16x16x32_bf16 v[104:107], v[36:39], v[84:87], v[104:107]
    s_waitcnt lgkmcnt(2)
    v_mfma_f32_16x16x32_bf16 v[104:107], v[40:43], v[88:91], v[104:107]
    s_waitcnt lgkmcnt(0)
    v_mfma_f32_16x16x32_bf16 v[104:107], v[44:47], v[92:95], v[104:107]
    v_xor_b32 v55, 96, v53
    ds_read_b64_tr_b16 v[16:17], v55 offset:0
    ds_read_b64_tr_b16 v[18:19], v55 offset:2048
    ds_read_b64_tr_b16 v[20:21], v55 offset:4096
    ds_read_b64_tr_b16 v[22:23], v55 offset:6144
    ds_read_b64_tr_b16 v[24:25], v55 offset:8192
    ds_read_b64_tr_b16 v[26:27], v55 offset:10240
    ds_read_b64_tr_b16 v[28:29], v55 offset:12288
    ds_read_b64_tr_b16 v[30:31], v55 offset:14336
    s_waitcnt lgkmcnt(6)
    v_mfma_f32_16x16x32_bf16 v[108:111], v[16:19], v[64:67], 0
    s_waitcnt lgkmcnt(4)
    v_mfma_f32_16x16x32_bf16 v[108:111], v[20:23], v[68:71], v[108:111]
    s_waitcnt lgkmcnt(2)
    v_mfma_f32_16x16x32_bf16 v[108:111], v[24:27], v[72:75], v[108:111]
    s_waitcnt lgkmcnt(0)
    v_mfma_f32_16x16x32_bf16 v[108:111], v[28:31], v[76:79], v[108:111]
    ds_read_b64_tr_b16 v[32:33], v55 offset:16384
    ds_read_b64_tr_b16 v[34:35], v55 offset:18432
    ds_read_b64_tr_b16 v[36:37], v55 offset:20480
    ds_read_b64_tr_b16 v[38:39], v55 offset:22528
    ds_read_b64_tr_b16 v[40:41], v55 offset:24576
    ds_read_b64_tr_b16 v[42:43], v55 offset:26624
    ds_read_b64_tr_b16 v[44:45], v55 offset:28672
    ds_read_b64_tr_b16 v[46:47], v55 offset:30720
    s_waitcnt lgkmcnt(6)
    v_mfma_f32_16x16x32_bf16 v[108:111], v[32:35], v[80:83], v[108:111]
    s_waitcnt lgkmcnt(4)
    v_mfma_f32_16x16x32_bf16 v[108:111], v[36:39], v[84:87], v[108:111]
    s_waitcnt lgkmcnt(2)
    v_mfma_f32_16x16x32_bf16 v[108:111], v[40:43], v[88:91], v[108:111]
    s_waitcnt lgkmcnt(0)
    v_mfma_f32_16x16x32_bf16 v[108:111], v[44:47], v[92:95], v[108:111]
    s_mov_b64 exec, 1
    ds_add_u32 v3, v5 offset:24
    s_mov_b64 exec, -1
    s_nop 5
    v_cvt_pk_bf16_f32 v96, v96, v97
    v_cvt_pk_bf16_f32 v98, v98, v99
    v_cvt_pk_bf16_f32 v100, v100, v101
    v_cvt_pk_bf16_f32 v102, v102, v103
    v_cndmask_b32 v16, v100, v96, s[58:59]
    v_mov_b32 v17, s34
    v_cndmask_b32 v18, v102, v98, s[58:59]
    v_mov_b32 v19, s34
    global_store_dwordx4 v54, v[16:19], s[26:27] offset:0
    v_cvt_pk_bf16_f32 v104, v104, v105
    v_cvt_pk_bf16_f32 v106, v106, v107
    v_cvt_pk_bf16_f32 v108, v108, v109
    v_cvt_pk_bf16_f32 v110, v110, v111
    v_cndmask_b32 v20, v108, v104, s[58:59]
    v_mov_b32 v21, s34
    v_cndmask_b32 v22, v110, v106, s[58:59]
    v_mov_b32 v23, s34
    global_store_dwordx4 v54, v[20:23], s[26:27] offset:128
    s_mov_b32 s61, 0
WL_78:
    ds_read_b32 v4, v3 offset:12
    s_waitcnt lgkmcnt(0)
    v_readfirstlane_b32 s60, v4
    s_add_u32 s61, s61, 1
    s_cmp_ge_i32 s60, 4
    s_cbranch_scc1 WD_79
    s_sleep 4
    s_cmp_lt_u32 s61, 1048576
    s_cbranch_scc1 WL_78
WD_79:
    ds_read_b32 v4, v3 offset:36
    s_waitcnt lgkmcnt(0)
    v_readfirstlane_b32 s76, v4
    s_cmp_eq_u32 s76, 0
    s_cbranch_scc1 L_final
    global_store_dwordx4 v54, v[16:19], s[26:27] offset:0 sc1
    global_store_dwordx4 v54, v[20:23], s[26:27] offset:128 sc1
    s_branch L_final
L_dunit:
    s_mov_b32 s50, s68
    s_lshl_b32 s48, s50, 12
    s_add_u32 s48, s48, 1179648
    v_lshlrev_b32 v52, 8, v112
    v_lshl_add_u32 v52, v113, 7, v52
    v_lshl_add_u32 v52, v2, 4, v52
    v_add_u32 v52, s48, v52
    v_add_u32 v53, 114688, v52
    s_add_u32 s48, s36, 0
    s_mov_b32 s61, 0
WL_80:
    ds_read_b32 v4, v3 offset:0
    s_waitcnt lgkmcnt(0)
    v_readfirstlane_b32 s60, v4
    s_add_u32 s61, s61, 1
    s_cmp_ge_i32 s60, s48
    s_cbranch_scc1 WD_81
    s_sleep 1
    s_cmp_lt_u32 s61, 1048576
    s_cbranch_scc1 WL_80
WD_81:
    s_mov_b32 s61, 0
    s_mov_b64 s[64:65], -1
PL_82:
    s_mov_b64 exec, s[64:65]
    s_cmp_ge_u32 s61, 16
    s_cbranch_scc1 PS_85
    global_load_dwordx4 v[16:19], v52, s[26:27] offset:0 nt
    global_load_dwordx4 v[20:23], v52, s[26:27] offset:64 nt
    global_load_dwordx4 v[24:27], v52, s[26:27] offset:2048 nt
    global_load_dwordx4 v[28:31], v52, s[26:27] offset:2112 nt
    global_load_dwordx4 v[32:35], v53, s[26:27] offset:0 nt
    global_load_dwordx4 v[36:39], v53, s[26:27] offset:64 nt
    global_load_dwordx4 v[40:43], v53, s[26:27] offset:2048 nt
    global_load_dwordx4 v[44:47], v53, s[26:27] offset:2112 nt
    s_mov_b64 exec, -1
    s_branch PC_84
PS_85:
    global_load_dwordx4 v[16:19], v52, s[26:27] offset:0 sc1
    global_load_dwordx4 v[20:23], v52, s[26:27] offset:64 sc1
    global_load_dwordx4 v[24:27], v52, s[26:27] offset:2048 sc1
    global_load_dwordx4 v[28:31], v52, s[26:27] offset:2112 sc1
    global_load_dwordx4 v[32:35], v53, s[26:27] offset:0 sc1
    global_load_dwordx4 v[36:39], v53, s[26:27] offset:64 sc1
    global_load_dwordx4 v[40:43], v53, s[26:27] offset:2048 sc1
    global_load_dwordx4 v[44:47], v53, s[26:27] offset:2112 sc1
    s_mov_b64 exec, -1
PC_84:
    s_waitcnt vmcnt(0)
    v_xor_b32 v54, s34, v17
    v_xor_b32 v55, s34, v19
    v_xor_b32 v119, s34, v21
    v_or3_b32 v54, v54, v55, v119
    v_xor_b32 v55, s34, v23
    v_xor_b32 v119, s34, v25
    v_or3_b32 v54, v54, v55, v119
    v_xor_b32 v55, s34, v27
    v_xor_b32 v119, s34, v29
    v_or3_b32 v54, v54, v55, v119
    v_xor_b32 v55, s34, v31
    v_xor_b32 v119, s34, v33
    v_or3_b32 v54, v54, v55, v119
    v_xor_b32 v55, s34, v35
    v_xor_b32 v119, s34, v37
    v_or3_b32 v54, v54, v55, v119
    v_xor_b32 v55, s34, v39
    v_xor_b32 v119, s34, v41
    v_or3_b32 v54, v54, v55, v119
    v_xor_b32 v55, s34, v43
    v_xor_b32 v119, s34, v45
    v_or3_b32 v54, v54, v55, v119
    v_xor_b32 v55, s34, v47
    v_or_b32 v54, v54, v55
    v_cmp_ne_u32 s[64:65], 0, v54
    s_cmp_eq_u64 s[64:65], 0
    s_cbranch_scc1 PD_83
    s_add_u32 s61, s61, 1
    s_sleep 8
    s_cmp_lt_u32 s61, 131072
    s_cbranch_scc1 PL_82
PD_83:
    v_lshlrev_b32 v56, 16, v16
    v_lshlrev_b32 v57, 16, v24
    v_add_f32 v56, v56, v57
    v_lshlrev_b32 v58, 16, v32
    v_lshlrev_b32 v57, 16, v40
    v_add_f32 v58, v58, v57
    v_cvt_pk_bf16_f32 v57, v56, v58
    v_lshlrev_b32 v56, 16, v57
    v_and_b32 v58, 0xffff0000, v57
    v_mul_f32 v57, 0xbfb8aa3b, v56
    v_exp_f32 v57, v57
    s_nop 0
    v_add_f32 v57, 1.0, v57
    v_rcp_f32 v57, v57
    s_nop 0
    v_mul_f32 v56, v56, v57
    v_cvt_pk_bf16_f32 v56, v56, v56
    v_lshlrev_b32 v56, 16, v56
    v_mul_f32 v60, v56, v58
    v_and_b32 v56, 0xffff0000, v16
    v_and_b32 v57, 0xffff0000, v24
    v_add_f32 v56, v56, v57
    v_and_b32 v58, 0xffff0000, v32
    v_and_b32 v57, 0xffff0000, v40
    v_add_f32 v58, v58, v57
    v_cvt_pk_bf16_f32 v57, v56, v58
    v_lshlrev_b32 v56, 16, v57
    v_and_b32 v58, 0xffff0000, v57
    v_mul_f32 v57, 0xbfb8aa3b, v56
    v_exp_f32 v57, v57
    s_nop 0
    v_add_f32 v57, 1.0, v57
    v_rcp_f32 v57, v57
    s_nop 0
    v_mul_f32 v56, v56, v57
    v_cvt_pk_bf16_f32 v56, v56, v56
    v_lshlrev_b32 v56, 16, v56
    v_mul_f32 v61, v56, v58
    v_cvt_pk_bf16_f32 v64, v60, v61
    v_lshlrev_b32 v56, 16, v18
    v_lshlrev_b32 v57, 16, v26
    v_add_f32 v56, v56, v57
    v_lshlrev_b32 v58, 16, v34
    v_lshlrev_b32 v57, 16, v42
    v_add_f32 v58, v58, v57
    v_cvt_pk_bf16_f32 v57, v56, v58
    v_lshlrev_b32 v56, 16, v57
    v_and_b32 v58, 0xffff0000, v57
    v_mul_f32 v57, 0xbfb8aa3b, v56
    v_exp_f32 v57, v57
    s_nop 0
    v_add_f32 v57, 1.0, v57
    v_rcp_f32 v57, v57
    s_nop 0
    v_mul_f32 v56, v56, v57
    v_cvt_pk_bf16_f32 v56, v56, v56
    v_lshlrev_b32 v56, 16, v56
    v_mul_f32 v60, v56, v58
    v_and_b32 v56, 0xffff0000, v18
    v_and_b32 v57, 0xffff0000, v26
    v_add_f32 v56, v56, v57
    v_and_b32 v58, 0xffff0000, v34
    v_and_b32 v57, 0xffff0000, v42
    v_add_f32 v58, v58, v57
    v_cvt_pk_bf16_f32 v57, v56, v58
    v_lshlrev_b32 v56, 16, v57
    v_and_b32 v58, 0xffff0000, v57
    v_mul_f32 v57, 0xbfb8aa3b, v56
    v_exp_f32 v57, v57
    s_nop 0
    v_add_f32 v57, 1.0, v57
    v_rcp_f32 v57, v57
    s_nop 0
    v_mul_f32 v56, v56, v57
    v_cvt_pk_bf16_f32 v56, v56, v56
    v_lshlrev_b32 v56, 16, v56
    v_mul_f32 v61, v56, v58
    v_cvt_pk_bf16_f32 v65, v60, v61
    v_lshlrev_b32 v56, 16, v20
    v_lshlrev_b32 v57, 16, v28
    v_add_f32 v56, v56, v57
    v_lshlrev_b32 v58, 16, v36
    v_lshlrev_b32 v57, 16, v44
    v_add_f32 v58, v58, v57
    v_cvt_pk_bf16_f32 v57, v56, v58
    v_lshlrev_b32 v56, 16, v57
    v_and_b32 v58, 0xffff0000, v57
    v_mul_f32 v57, 0xbfb8aa3b, v56
    v_exp_f32 v57, v57
    s_nop 0
    v_add_f32 v57, 1.0, v57
    v_rcp_f32 v57, v57
    s_nop 0
    v_mul_f32 v56, v56, v57
    v_cvt_pk_bf16_f32 v56, v56, v56
    v_lshlrev_b32 v56, 16, v56
    v_mul_f32 v60, v56, v58
    v_and_b32 v56, 0xffff0000, v20
    v_and_b32 v57, 0xffff0000, v28
    v_add_f32 v56, v56, v57
    v_and_b32 v58, 0xffff0000, v36
    v_and_b32 v57, 0xffff0000, v44
    v_add_f32 v58, v58, v57
    v_cvt_pk_bf16_f32 v57, v56, v58
    v_lshlrev_b32 v56, 16, v57
    v_and_b32 v58, 0xffff0000, v57
    v_mul_f32 v57, 0xbfb8aa3b, v56
    v_exp_f32 v57, v57
    s_nop 0
    v_add_f32 v57, 1.0, v57
    v_rcp_f32 v57, v57
    s_nop 0
    v_mul_f32 v56, v56, v57
    v_cvt_pk_bf16_f32 v56, v56, v56
    v_lshlrev_b32 v56, 16, v56
    v_mul_f32 v61, v56, v58
    v_cvt_pk_bf16_f32 v66, v60, v61
    v_lshlrev_b32 v56, 16, v22
    v_lshlrev_b32 v57, 16, v30
    v_add_f32 v56, v56, v57
    v_lshlrev_b32 v58, 16, v38
    v_lshlrev_b32 v57, 16, v46
    v_add_f32 v58, v58, v57
    v_cvt_pk_bf16_f32 v57, v56, v58
    v_lshlrev_b32 v56, 16, v57
    v_and_b32 v58, 0xffff0000, v57
    v_mul_f32 v57, 0xbfb8aa3b, v56
    v_exp_f32 v57, v57
    s_nop 0
    v_add_f32 v57, 1.0, v57
    v_rcp_f32 v57, v57
    s_nop 0
    v_mul_f32 v56, v56, v57
    v_cvt_pk_bf16_f32 v56, v56, v56
    v_lshlrev_b32 v56, 16, v56
    v_mul_f32 v60, v56, v58
    v_and_b32 v56, 0xffff0000, v22
    v_and_b32 v57, 0xffff0000, v30
    v_add_f32 v56, v56, v57
    v_and_b32 v58, 0xffff0000, v38
    v_and_b32 v57, 0xffff0000, v46
    v_add_f32 v58, v58, v57
    v_cvt_pk_bf16_f32 v57, v56, v58
    v_lshlrev_b32 v56, 16, v57
    v_and_b32 v58, 0xffff0000, v57
    v_mul_f32 v57, 0xbfb8aa3b, v56
    v_exp_f32 v57, v57
    s_nop 0
    v_add_f32 v57, 1.0, v57
    v_rcp_f32 v57, v57
    s_nop 0
    v_mul_f32 v56, v56, v57
    v_cvt_pk_bf16_f32 v56, v56, v56
    v_lshlrev_b32 v56, 16, v56
    v_mul_f32 v61, v56, v58
    v_cvt_pk_bf16_f32 v67, v60, v61
    v_add_u32 v53, 131072, v51
    s_lshl_b32 s48, s69, 8
    s_add_u32 s48, s48, s50
    s_lshl_b32 s48, s48, 7
    s_add_u32 s48, s48, 3145728
    v_lshlrev_b32 v54, 17, v112
    v_lshl_add_u32 v54, v2, 5, v54
    v_lshl_add_u32 v54, v113, 4, v54
    v_add_u32 v54, s48, v54
    s_mov_b32 s61, 0
WL_86:
    ds_read_b32 v4, v3 offset:0
    s_waitcnt lgkmcnt(0)
    v_readfirstlane_b32 s60, v4
    s_add_u32 s61, s61, 1
    s_cmp_ge_i32 s60, s38
    s_cbranch_scc1 WD_87
    s_sleep 1
    s_cmp_lt_u32 s61, 1048576
    s_cbranch_scc1 WL_86
WD_87:
    v_xor_b32 v55, 0, v53
    ds_read_b64_tr_b16 v[16:17], v55 offset:0
    ds_read_b64_tr_b16 v[18:19], v55 offset:4096
    ds_read_b64_tr_b16 v[20:21], v55 offset:8192
    ds_read_b64_tr_b16 v[22:23], v55 offset:12288
    v_xor_b32 v55, 32, v53
    ds_read_b64_tr_b16 v[24:25], v55 offset:0
    ds_read_b64_tr_b16 v[26:27], v55 offset:4096
    ds_read_b64_tr_b16 v[28:29], v55 offset:8192
    ds_read_b64_tr_b16 v[30:31], v55 offset:12288
    s_waitcnt lgkmcnt(6)
    v_mfma_f32_16x16x32_bf16 v[72:75], v[16:19], v[64:67], 0
    s_waitcnt lgkmcnt(4)
    v_mfma_f32_16x16x32_bf16 v[76:79], v[20:23], v[64:67], 0
    s_waitcnt lgkmcnt(2)
    v_mfma_f32_16x16x32_bf16 v[80:83], v[24:27], v[64:67], 0
    s_waitcnt lgkmcnt(0)
    v_mfma_f32_16x16x32_bf16 v[84:87], v[28:31], v[64:67], 0
    v_xor_b32 v55, 64, v53
    ds_read_b64_tr_b16 v[32:33], v55 offset:0
    ds_read_b64_tr_b16 v[34:35], v55 offset:4096
    ds_read_b64_tr_b16 v[36:37], v55 offset:8192
    ds_read_b64_tr_b16 v[38:39], v55 offset:12288
    v_xor_b32 v55, 96, v53
    ds_read_b64_tr_b16 v[40:41], v55 offset:0
    ds_read_b64_tr_b16 v[42:43], v55 offset:4096
    ds_read_b64_tr_b16 v[44:45], v55 offset:8192
    ds_read_b64_tr_b16 v[46:47], v55 offset:12288
    s_waitcnt lgkmcnt(6)
    v_mfma_f32_16x16x32_bf16 v[88:91], v[32:35], v[64:67], 0
    s_waitcnt lgkmcnt(4)
    v_mfma_f32_16x16x32_bf16 v[92:95], v[36:39], v[64:67], 0
    s_waitcnt lgkmcnt(2)
    v_mfma_f32_16x16x32_bf16 v[96:99], v[40:43], v[64:67], 0
    s_waitcnt lgkmcnt(0)
    v_mfma_f32_16x16x32_bf16 v[100:103], v[44:47], v[64:67], 0
    s_nop 7
    v_add_f32_dpp v56, v76, v72 row_ror:8 row_mask:0xf bank_mask:0xf
    v_add_f32_dpp v57, v77, v73 row_ror:8 row_mask:0xf bank_mask:0xf
    v_add_f32_dpp v58, v74, v78 row_ror:8 row_mask:0xf bank_mask:0xf
    v_add_f32_dpp v59, v75, v79 row_ror:8 row_mask:0xf bank_mask:0xf
    v_cndmask_b32 v104, v58, v56, s[58:59]
    v_cndmask_b32 v105, v59, v57, s[58:59]
    v_add_f32_dpp v56, v84, v80 row_ror:8 row_mask:0xf bank_mask:0xf
    v_add_f32_dpp v57, v85, v81 row_ror:8 row_mask:0xf bank_mask:0xf
    v_add_f32_dpp v58, v82, v86 row_ror:8 row_mask:0xf bank_mask:0xf
    v_add_f32_dpp v59, v83, v87 row_ror:8 row_mask:0xf bank_mask:0xf
    v_cndmask_b32 v106, v58, v56, s[58:59]
    v_cndmask_b32 v107, v59, v57, s[58:59]
    v_add_f32_dpp v56, v92, v88 row_ror:8 row_mask:0xf bank_mask:0xf
    v_add_f32_dpp v57, v93, v89 row_ror:8 row_mask:0xf bank_mask:0xf
    v_add_f32_dpp v58, v90, v94 row_ror:8 row_mask:0xf bank_mask:0xf
    v_add_f32_dpp v59, v91, v95 row_ror:8 row_mask:0xf bank_mask:0xf
    v_cndmask_b32 v108, v58, v56, s[58:59]
    v_cndmask_b32 v109, v59, v57, s[58:59]
    v_add_f32_dpp v56, v100, v96 row_ror:8 row_mask:0xf bank_mask:0xf
    v_add_f32_dpp v57, v101, v97 row_ror:8 row_mask:0xf bank_mask:0xf
    v_add_f32_dpp v58, v98, v102 row_ror:8 row_mask:0xf bank_mask:0xf
    v_add_f32_dpp v59, v99, v103 row_ror:8 row_mask:0xf bank_mask:0xf
    v_cndmask_b32 v110, v58, v56, s[58:59]
    v_cndmask_b32 v111, v59, v57, s[58:59]
    s_nop 1
    v_xor_b32 v55, 128, v53
    ds_read_b64_tr_b16 v[16:17], v55 offset:0
    ds_read_b64_tr_b16 v[18:19], v55 offset:4096
    ds_read_b64_tr_b16 v[20:21], v55 offset:8192
    ds_read_b64_tr_b16 v[22:23], v55 offset:12288
    v_xor_b32 v55, 160, v53
    ds_read_b64_tr_b16 v[24:25], v55 offset:0
    ds_read_b64_tr_b16 v[26:27], v55 offset:4096
    ds_read_b64_tr_b16 v[28:29], v55 offset:8192
    ds_read_b64_tr_b16 v[30:31], v55 offset:12288
    s_waitcnt lgkmcnt(6)
    v_mfma_f32_16x16x32_bf16 v[72:75], v[16:19], v[64:67], 0
    s_waitcnt lgkmcnt(4)
    v_mfma_f32_16x16x32_bf16 v[76:79], v[20:23], v[64:67], 0
    s_waitcnt lgkmcnt(2)
    v_mfma_f32_16x16x32_bf16 v[80:83], v[24:27], v[64:67], 0
    s_waitcnt lgkmcnt(0)
    v_mfma_f32_16x16x32_bf16 v[84:87], v[28:31], v[64:67], 0
    v_xor_b32 v55, 192, v53
    ds_read_b64_tr_b16 v[32:33], v55 offset:0
    ds_read_b64_tr_b16 v[34:35], v55 offset:4096
    ds_read_b64_tr_b16 v[36:37], v55 offset:8192
    ds_read_b64_tr_b16 v[38:39], v55 offset:12288
    v_xor_b32 v55, 224, v53
    ds_read_b64_tr_b16 v[40:41], v55 offset:0
    ds_read_b64_tr_b16 v[42:43], v55 offset:4096
    ds_read_b64_tr_b16 v[44:45], v55 offset:8192
    ds_read_b64_tr_b16 v[46:47], v55 offset:12288
    s_waitcnt lgkmcnt(6)
    v_mfma_f32_16x16x32_bf16 v[88:91], v[32:35], v[64:67], 0
    s_waitcnt lgkmcnt(4)
    v_mfma_f32_16x16x32_bf16 v[92:95], v[36:39], v[64:67], 0
    s_waitcnt lgkmcnt(2)
    v_mfma_f32_16x16x32_bf16 v[96:99], v[40:43], v[64:67], 0
    s_waitcnt lgkmcnt(0)
    v_mfma_f32_16x16x32_bf16 v[100:103], v[44:47], v[64:67], 0
    s_nop 7
    v_add_f32_dpp v56, v76, v72 row_ror:8 row_mask:0xf bank_mask:0xf
    v_add_f32_dpp v57, v77, v73 row_ror:8 row_mask:0xf bank_mask:0xf
    v_add_f32_dpp v58, v74, v78 row_ror:8 row_mask:0xf bank_mask:0xf
    v_add_f32_dpp v59, v75, v79 row_ror:8 row_mask:0xf bank_mask:0xf
    v_cndmask_b32 v114, v58, v56, s[58:59]
    v_cndmask_b32 v115, v59, v57, s[58:59]
    v_add_f32_dpp v56, v84, v80 row_ror:8 row_mask:0xf bank_mask:0xf
    v_add_f32_dpp v57, v85, v81 row_ror:8 row_mask:0xf bank_mask:0xf
    v_add_f32_dpp v58, v82, v86 row_ror:8 row_mask:0xf bank_mask:0xf
    v_add_f32_dpp v59, v83, v87 row_ror:8 row_mask:0xf bank_mask:0xf
    v_cndmask_b32 v116, v58, v56, s[58:59]
    v_cndmask_b32 v117, v59, v57, s[58:59]
    v_add_f32_dpp v56, v92, v88 row_ror:8 row_mask:0xf bank_mask:0xf
    v_add_f32_dpp v57, v93, v89 row_ror:8 row_mask:0xf bank_mask:0xf
    v_add_f32_dpp v58, v90, v94 row_ror:8 row_mask:0xf bank_mask:0xf
    v_add_f32_dpp v59, v91, v95 row_ror:8 row_mask:0xf bank_mask:0xf
    v_cndmask_b32 v124, v58, v56, s[58:59]
    v_cndmask_b32 v125, v59, v57, s[58:59]
    v_add_f32_dpp v56, v100, v96 row_ror:8 row_mask:0xf bank_mask:0xf
    v_add_f32_dpp v57, v101, v97 row_ror:8 row_mask:0xf bank_mask:0xf
    v_add_f32_dpp v58, v98, v102 row_ror:8 row_mask:0xf bank_mask:0xf
    v_add_f32_dpp v59, v99, v103 row_ror:8 row_mask:0xf bank_mask:0xf
    v_cndmask_b32 v126, v58, v56, s[58:59]
    v_cndmask_b32 v127, v59, v57, s[58:59]
    s_nop 1
    v_mov_b32 v16, v104
    v_mov_b32 v17, s34
    v_mov_b32 v18, v105
    v_mov_b32 v19, s34
    v_add_u32 v55, 0, v54
    global_store_dwordx4 v55, v[16:19], s[26:27] sc1
    v_mov_b32 v20, v106
    v_mov_b32 v21, s34
    v_mov_b32 v22, v107
    v_mov_b32 v23, s34
    v_add_u32 v55, 4096, v54
    global_store_dwordx4 v55, v[20:23], s[26:27] sc1
    v_mov_b32 v24, v108
    v_mov_b32 v25, s34
    v_mov_b32 v26, v109
    v_mov_b32 v27, s34
    v_add_u32 v55, 8192, v54
    global_store_dwordx4 v55, v[24:27], s[26:27] sc1
    v_mov_b32 v28, v110
    v_mov_b32 v29, s34
    v_mov_b32 v30, v111
    v_mov_b32 v31, s34
    v_add_u32 v55, 12288, v54
    global_store_dwordx4 v55, v[28:31], s[26:27] sc1
    v_mov_b32 v32, v114
    v_mov_b32 v33, s34
    v_mov_b32 v34, v115
    v_mov_b32 v35, s34
    v_add_u32 v55, 16384, v54
    global_store_dwordx4 v55, v[32:35], s[26:27] sc1
    v_mov_b32 v36, v116
    v_mov_b32 v37, s34
    v_mov_b32 v38, v117
    v_mov_b32 v39, s34
    v_add_u32 v55, 20480, v54
    global_store_dwordx4 v55, v[36:39], s[26:27] sc1
    v_mov_b32 v40, v124
    v_mov_b32 v41, s34
    v_mov_b32 v42, v125
    v_mov_b32 v43, s34
    v_add_u32 v55, 24576, v54
    global_store_dwordx4 v55, v[40:43], s[26:27] sc1
    v_mov_b32 v44, v126
    v_mov_b32 v45, s34
    v_mov_b32 v46, v127
    v_mov_b32 v47, s34
    v_add_u32 v55, 28672, v54
    global_store_dwordx4 v55, v[44:47], s[26:27] sc1
    s_nop 1
L_final:
    s_mov_b32 s61, 0
WL_88:
    ds_read_b32 v4, v3 offset:0
    s_waitcnt lgkmcnt(0)
    v_readfirstlane_b32 s60, v4
    s_add_u32 s61, s61, 1
    s_cmp_ge_i32 s60, s37
    s_cbranch_scc1 WD_89
    s_sleep 1
    s_cmp_lt_u32 s61, 1048576
    s_cbranch_scc1 WL_88
WD_89:
    s_mov_b32 s61, 0
    v_mov_b32 v28, 0
    v_mov_b32 v29, s34
    v_mov_b32 v30, 0
    v_mov_b32 v31, s34
    s_mov_b64 s[64:65], -1
PL_90:
    s_mov_b64 exec, s[64:65]
    global_load_dwordx4 v[16:19], v11, s[26:27] offset:0 sc1
    global_load_dwordx4 v[20:23], v11, s[26:27] offset:1024 sc1
    global_load_dwordx4 v[24:27], v11, s[26:27] offset:2048 sc1
    s_mov_b32 exec_hi, 0
    global_load_dwordx4 v[28:31], v11, s[26:27] offset:3072 sc1
    s_mov_b64 exec, -1
PC_92:
    s_waitcnt vmcnt(0)
    v_xor_b32 v12, s34, v17
    v_xor_b32 v13, s34, v19
    v_xor_b32 v119, s34, v21
    v_or3_b32 v12, v12, v13, v119
    v_xor_b32 v13, s34, v23
    v_xor_b32 v119, s34, v25
    v_or3_b32 v12, v12, v13, v119
    v_xor_b32 v13, s34, v27
    v_xor_b32 v119, s34, v29
    v_or3_b32 v12, v12, v13, v119
    v_xor_b32 v13, s34, v31
    v_or_b32 v12, v12, v13
    v_cmp_ne_u32 s[64:65], 0, v12
    s_cmp_eq_u64 s[64:65], 0
    s_cbranch_scc1 PD_91
    s_add_u32 s61, s61, 1
    s_sleep 4
    s_cmp_lt_u32 s61, 131072
    s_cbranch_scc1 PL_90
PD_91:
    v_add_f32 v32, v16, v20
    v_add_f32 v33, v18, v22
    v_add_f32 v34, v24, v28
    v_add_f32 v35, v26, v30
    v_add_f32 v32, v32, v34
    v_add_f32 v33, v33, v35
    s_nop 1
    v_add_f32_dpp v32, v32, v32 row_ror:8 row_mask:0xf bank_mask:0xf
    v_add_f32_dpp v33, v33, v33 row_ror:8 row_mask:0xf bank_mask:0xf
    v_mov_b32 v34, v32
    v_mov_b32 v35, v33
    s_nop 1
    v_permlane16_swap_b32 v32, v34
    v_permlane16_swap_b32 v33, v35
    s_nop 0
    v_add_f32 v32, v32, v34
    v_add_f32 v33, v33, v35
    v_mov_b32 v34, v32
    v_mov_b32 v35, v33
    s_nop 1
    v_permlane32_swap_b32 v32, v34
    v_permlane32_swap_b32 v33, v35
    s_nop 0
    v_add_f32 v32, v32, v34
    v_add_f32 v33, v33, v35
    v_cvt_pk_bf16_f32 v34, v32, v33
    v_lshlrev_b32 v32, 16, v34
    v_and_b32 v33, 0xffff0000, v34
    v_mul_f32 v34, 0xbfb8aa3b, v32
    v_exp_f32 v34, v34
    s_nop 0
    v_add_f32 v34, 1.0, v34
    v_rcp_f32 v34, v34
    s_nop 0
    v_mul_f32 v32, v32, v34
    v_mul_f32 v34, 0xbfb8aa3b, v33
    v_exp_f32 v34, v34
    s_nop 0
    v_add_f32 v34, 1.0, v34
    v_rcp_f32 v34, v34
    s_nop 0
    v_mul_f32 v33, v33, v34
    v_cvt_pk_bf16_f32 v34, v32, v33
    v_lshlrev_b32 v32, 16, v34
    v_and_b32 v33, 0xffff0000, v34
    v_lshlrev_b32 v8, 16, v7
    v_and_b32 v9, 0xffff0000, v7
    s_mov_b32 s61, 0
WL_93:
    ds_read_b32 v4, v3 offset:28
    s_waitcnt lgkmcnt(0)
    v_readfirstlane_b32 s60, v4
    s_add_u32 s61, s61, 1
    s_cmp_ge_i32 s60, 4
    s_cbranch_scc1 WD_94
    s_sleep 1
    s_cmp_lt_u32 s61, 1048576
    s_cbranch_scc1 WL_93
WD_94:
    s_sleep 22
    s_mov_b32 s61, 0
    s_mov_b64 s[64:65], -1
PL_95:
    s_mov_b64 exec, s[64:65]
    global_load_dwordx4 v[16:19], v10, s[26:27] offset:0 sc1
    global_load_dwordx4 v[20:23], v10, s[26:27] offset:1024 sc1
    global_load_dwordx4 v[24:27], v10, s[26:27] offset:2048 sc1
    global_load_dwordx4 v[28:31], v10, s[26:27] offset:3072 sc1
    s_mov_b64 exec, -1
PC_97:
    s_waitcnt vmcnt(0)
    v_xor_b32 v12, s34, v17
    v_xor_b32 v13, s34, v19
    v_xor_b32 v119, s34, v21
    v_or3_b32 v12, v12, v13, v119
    v_xor_b32 v13, s34, v23
    v_xor_b32 v119, s34, v25
    v_or3_b32 v12, v12, v13, v119
    v_xor_b32 v13, s34, v27
    v_xor_b32 v119, s34, v29
    v_or3_b32 v12, v12, v13, v119
    v_xor_b32 v13, s34, v31
    v_or_b32 v12, v12, v13
    v_cmp_ne_u32 s[64:65], 0, v12
    s_cmp_eq_u64 s[64:65], 0
    s_cbranch_scc1 PD_96
    s_add_u32 s61, s61, 1
    s_sleep 1
    s_cmp_lt_u32 s61, 131072
    s_cbranch_scc1 PL_95
PD_96:
    v_add_f32 v36, v16, v20
    v_add_f32 v37, v18, v22
    v_add_f32 v34, v24, v28
    v_add_f32 v35, v26, v30
    v_add_f32 v36, v36, v34
    v_add_f32 v37, v37, v35
    s_nop 1
    v_add_f32_dpp v36, v36, v36 row_ror:8 row_mask:0xf bank_mask:0xf
    v_add_f32_dpp v37, v37, v37 row_ror:8 row_mask:0xf bank_mask:0xf
    v_mov_b32 v34, v36
    v_mov_b32 v35, v37
    s_nop 1
    v_permlane16_swap_b32 v36, v34
    v_permlane16_swap_b32 v37, v35
    s_nop 0
    v_add_f32 v36, v36, v34
    v_add_f32 v37, v37, v35
    v_mov_b32 v34, v36
    v_mov_b32 v35, v37
    s_nop 1
    v_permlane32_swap_b32 v36, v34
    v_permlane32_swap_b32 v37, v35
    s_nop 0
    v_add_f32 v36, v36, v34
    v_add_f32 v37, v37, v35
    v_cvt_pk_bf16_f32 v34, v36, v37
    v_lshlrev_b32 v36, 16, v34
    v_and_b32 v37, 0xffff0000, v34
    v_mul_f32 v36, v36, v32
    v_mul_f32 v37, v37, v33
    v_cvt_pk_bf16_f32 v34, v36, v37
    v_lshlrev_b32 v36, 16, v34
    v_and_b32 v37, 0xffff0000, v34
    v_add_f32 v36, v36, v8
    v_add_f32 v37, v37, v9
    v_cvt_pk_bf16_f32 v34, v36, v37
    s_mov_b64 exec, 0xff
    global_store_dword v6, v34, s[22:23]
    s_cmp_lg_u32 s2, 0
    s_cbranch_scc1 L_noep
    s_mov_b64 exec, 1
    v_mov_b32 v35, s34
    v_mov_b32 v36, 0
    global_store_dword v36, v35, s[26:27] sc1
L_noep:
    s_mov_b64 exec, -1
L_end:
    s_endpgm
.section .rodata,"a"
.p2align 6
.amdhsa_kernel recurrent_scan__sliding_block_cached__swiglu_ffn__decode_kernel
  .amdhsa_next_free_vgpr 128
  .amdhsa_next_free_sgpr 102
  .amdhsa_accum_offset 128
  .amdhsa_group_segment_fixed_size 0
  .amdhsa_kernarg_size 96
  .amdhsa_user_sgpr_count 2
  .amdhsa_user_sgpr_kernarg_segment_ptr 1
  .amdhsa_system_sgpr_workgroup_id_x 1
.end_amdhsa_kernel
```
